```python
import torch

def _softmax(x, axis=-1):
    return torch.softmax(x, dim=axis)
def _gelu(x):
    return torch.nn.functional.gelu(x, approximate="tanh")
def _silu(x):
    return torch.nn.functional.silu(x)
def _sigmoid(x):
    return torch.sigmoid(x)
def _layernorm(x, axis=-1, eps=1e-5):
    m = x.mean(dim=axis, keepdim=True)
    v = x.var(dim=axis, keepdim=True, unbiased=False)
    return (x - m) / torch.sqrt(v + eps)
def _scatter_add(tgt, idx, src, axis=0):
    return tgt.clone().index_add_(axis, idx, src)
def _segment_sum(src, seg, n):
    out = torch.zeros((n,) + src.shape[1:], dtype=src.dtype)
    return out.index_add_(0, seg, src)
def _pad(x, pw):
    flat = tuple(v for pair in reversed(pw) for v in pair)
    return torch.nn.functional.pad(x, flat)

kernel_name = 'parallel_sum__ssm_conv_s5__dense_activation_relu__prompt'

def setup_inputs():

    _w = (lambda a: (lambda t: t.to(torch.bfloat16) if t.is_floating_point() else t)(torch.as_tensor(a)))
    def _A_setup():
        B, S, D = 1, 2048, 512
        P = D
        Lambda_re = -0.5 * (lambda _x: torch.exp(torch.as_tensor(_x)))((lambda *s: torch.randn(*s, dtype=torch.bfloat16) * 0.8)(P))
        Lambda_im = (lambda *s: torch.randn(*s, dtype=torch.bfloat16) * 0.8)(P) * 1.0
        B_re = (lambda *s: torch.randn(*s, dtype=torch.bfloat16) * 0.8)(P, D) * (D ** -0.5)
        B_im = (lambda *s: torch.randn(*s, dtype=torch.bfloat16) * 0.8)(P, D) * (D ** -0.5)
        C_re = (lambda *s: torch.randn(*s, dtype=torch.bfloat16) * 0.8)(D, P) * (P ** -0.5)
        C_im = (lambda *s: torch.randn(*s, dtype=torch.bfloat16) * 0.8)(D, P) * (P ** -0.5)
        log_dt = (lambda *s: torch.randn(*s, dtype=torch.bfloat16) * 0.8)(P) * 0.3 - 2.0
        Dskip = (lambda *s: torch.randn(*s, dtype=torch.bfloat16) * 0.8)(D)
        return {
            "x": _w((lambda *s: torch.randn(*s, dtype=torch.bfloat16) * 0.05)(B, S, D)),
            "Lambda_re": _w(Lambda_re),
            "Lambda_im": _w(Lambda_im),
            "B_re": _w(B_re),
            "B_im": _w(B_im),
            "C_re": _w(C_re),
            "C_im": _w(C_im),
            "log_dt": _w(log_dt),
            "Dskip": _w(Dskip),
        }
    _A_in = _A_setup()

    def _B_setup():
        B, S, D, Dff = 1, 2048, 512, 1376
        return {
            "x": _w((lambda *s: torch.randn(*s, dtype=torch.bfloat16) * 0.05)(B, S, D)),
            "w1": _w((lambda *s: torch.randn(*s, dtype=torch.bfloat16) * 0.05)(D, Dff)),
            "w2": _w((lambda *s: torch.randn(*s, dtype=torch.bfloat16) * 0.05)(Dff, D)),
        }
    _B_in = _B_setup()

    return {
        "A_x": _A_in["x"],
        "A_Lambda_re": _A_in["Lambda_re"],
        "A_Lambda_im": _A_in["Lambda_im"],
        "A_B_re": _A_in["B_re"],
        "A_B_im": _A_in["B_im"],
        "A_C_re": _A_in["C_re"],
        "A_C_im": _A_in["C_im"],
        "A_log_dt": _A_in["log_dt"],
        "A_Dskip": _A_in["Dskip"],
        "B_x": _B_in["x"],
        "B_w1": _B_in["w1"],
        "B_w2": _B_in["w2"],
    }

def reference(A_x, A_Lambda_re, A_Lambda_im, A_B_re, A_B_im, A_C_re, A_C_im, A_log_dt, A_Dskip, B_x, B_w1, B_w2):
    def _A_ref(x, Lambda_re, Lambda_im, B_re, B_im, C_re, C_im, log_dt, Dskip):
        Bsz, L, H = x.shape
        Lam = Lambda_re + 1j * Lambda_im
        Bmat = B_re + 1j * B_im
        Cmat = C_re + 1j * C_im
        dt = torch.exp(log_dt)
        Lam_bar = torch.exp(dt * Lam)
        B_bar = ((Lam_bar - 1.0) / Lam)[:, None] * Bmat
        Bu = torch.einsum("bld,pd->blp", x + 0j, B_bar)
        h = torch.zeros_like(Bu[:, 0, :])
        hs = []
        for t in range(L):
            h = Lam_bar[None, :] * h + Bu[:, t, :]
            hs.append(h)
        hseq = torch.stack(hs, 1)
        y = 2.0 * torch.einsum("blp,dp->bld", hseq, Cmat).real + x * Dskip[None, None, :]
        return y

    def _B_ref(x, w1, w2):
        h = torch.einsum("bsd,df->bsf", x, w1)
        zero = torch.zeros_like(h)
        h = torch.maximum(h, zero)
        return torch.einsum("bsf,fd->bsd", h, w2)

    x = A_x
    xn = _layernorm(x, axis=-1)
    return x + _A_ref(xn, A_Lambda_re, A_Lambda_im, A_B_re, A_B_im, A_C_re, A_C_im, A_log_dt, A_Dskip) + _B_ref(xn, B_w1, B_w2)
```

```asm
; @launch grid=(256,1,1) block=(256,1,1) lds=163840
.amdgcn_target "amdgcn-amd-amdhsa--gfx950"
.text
.globl parallel_sum__ssm_conv_s5__dense_activation_relu__prompt_kernel
.p2align 8
.type parallel_sum__ssm_conv_s5__dense_activation_relu__prompt_kernel,@function
parallel_sum__ssm_conv_s5__dense_activation_relu__prompt_kernel:
    s_cmp_ge_u32 s2, 0x100
    s_cbranch_scc1 L_END
    s_load_dwordx16 s[4:19], s[0:1], 0
    s_load_dwordx8 s[20:27], s[0:1], 64
    s_load_dwordx4 s[28:31], s[0:1], 96
    s_load_dwordx2 s[32:33], s[0:1], 112
    v_and_b32 v1, 63, v0
    v_lshrrev_b32 v80, 6, v0
    s_and_b32 s3, s2, 7
    s_lshr_b32 s78, s2, 3
    v_readfirstlane_b32 s70, v80
    s_lshr_b32 s68, s3, 1
    s_lshl_b32 s68, s68, 2
    s_lshr_b32 s35, s78, 3
    s_add_u32 s68, s68, s35
    s_and_b32 s74, s3, 1
    s_and_b32 s75, s78, 7
    s_add_u32 s76, s75, s35
    s_lshl_b32 s69, s74, 3
    s_add_u32 s69, s69, s75
    s_lshl_b32 s78, s78, 2
    s_add_u32 s78, s78, s70
    s_lshl_b32 s73, s68, 2
    s_add_u32 s73, s73, s70
    s_lshl_b32 s77, s70, 13
    s_mov_b32 s72, 0x10000
    s_getpc_b64 s[34:35]
L_PC:
    v_lshlrev_b32 v80, 7, v1
    v_add_u32 v80, s78, v80
    v_lshlrev_b32 v80, 7, v80
    v_min_u32 v80, L_END-L_PC, v80
    global_load_dword a254, v80, s[34:35]
    v_and_b32 v81, 31, v1
    v_lshrrev_b32 v82, 5, v1
    s_lshl_b32 s3, s68, 7
    s_lshl_b32 s34, s69, 3
    s_add_u32 s3, s3, s34
    s_lshl_b32 s34, s70, 1
    s_add_u32 s79, s3, s34
    v_add_u32 v85, s79, v82
    v_lshlrev_b32 v86, 10, v85
    v_lshl_add_u32 v86, v81, 4, v86
    s_lshl_b32 s3, s69, 6
    v_lshl_add_u32 v87, v81, 1, s3
    v_lshrrev_b32 v83, 3, v1
    v_and_b32 v84, 7, v1
    v_lshrrev_b32 v88, 4, v1
    v_xor_b32 v84, v88, v84
    v_lshlrev_b32 v84, 4, v84
    v_lshl_add_u32 v2, v83, 10, v84
    v_xor_b32 v3, 64, v2
    v_add_u32 v4, 14336, v2
    v_add_u32 v5, 21504, v3
    v_add_u32 v3, 7168, v3
    v_lshlrev_b32 v89, 4, v82
    v_and_b32 v90, 8, v1
    v_bfe_u32 v91, v1, 4, 1
    v_or3_b32 v89, v89, v90, v91
    v_lshl_add_u32 v6, v89, 10, v84
    v_xor_b32 v7, 64, v6
    v_add_u32 v8, 2048, v6
    v_add_u32 v9, 3072, v7
    v_add_u32 v7, 1024, v7
    s_waitcnt lgkmcnt(0)
    global_load_dwordx4 v[144:147], v86, s[4:5]
    global_load_dwordx4 v[148:151], v86, s[4:5] offset:512
    s_add_u32 s34, s32, 294912
    s_addc_u32 s35, s33, 0
    s_load_dword s71, s[34:35], 0
    s_mov_b32 s40, s10
    s_mov_b32 s41, s11
    s_mov_b32 s42, 524288
    s_mov_b32 s43, 0x20000
    s_mov_b32 s44, s12
    s_mov_b32 s45, s13
    s_mov_b32 s46, 524288
    s_mov_b32 s47, 0x20000
    s_mov_b32 s36, s4
    s_mov_b32 s37, s5
    s_mov_b32 s38, 2097152
    s_mov_b32 s39, 0x20000
    global_load_ushort v234, v87, s[6:7]
    global_load_ushort v235, v87, s[8:9]
    global_load_ushort v236, v87, s[18:19]
    s_lshl_b32 s7, s73, 15
    s_and_b32 s76, s76, 7
    s_lshl_b32 s3, s70, 1
    s_xor_b32 s76, s76, s3
    s_lshl_b32 s3, s76, 7
    s_add_u32 s78, s7, s3
    s_lshl_b32 s30, s69, 15
    s_add_u32 s30, s30, s3
    s_xor_b32 s31, s30, 128
    s_add_u32 m0, s77, 0
    s_nop 0
    buffer_load_dwordx4 v2, s[40:43], s30 offen lds
    buffer_load_dwordx4 v3, s[40:43], s30 offen offset:1024 lds
    buffer_load_dwordx4 v4, s[40:43], s30 offen offset:2048 lds
    buffer_load_dwordx4 v5, s[40:43], s30 offen offset:3072 lds
    s_add_u32 m0, s77, 32768
    s_nop 0
    buffer_load_dwordx4 v2, s[44:47], s30 offen lds
    buffer_load_dwordx4 v3, s[44:47], s30 offen offset:1024 lds
    buffer_load_dwordx4 v4, s[44:47], s30 offen offset:2048 lds
    buffer_load_dwordx4 v5, s[44:47], s30 offen offset:3072 lds
    s_xor_b32 s34, s78, 0
    s_add_u32 m0, s77, 98304
    s_nop 0
    buffer_load_dwordx4 v6, s[36:39], s34 offen lds
    buffer_load_dwordx4 v7, s[36:39], s34 offen offset:1024 lds
    buffer_load_dwordx4 v8, s[36:39], s34 offen offset:2048 lds
    buffer_load_dwordx4 v9, s[36:39], s34 offen offset:3072 lds
    s_mov_b32 s52, s24
    s_mov_b32 s53, s25
    s_mov_b32 s54, 1409024
    s_mov_b32 s55, 0x20000
    s_mov_b32 s56, s26
    s_mov_b32 s57, s27
    s_mov_b32 s58, 1409024
    s_mov_b32 s59, 0x20000
    s_mov_b32 s60, s32
    s_mov_b32 s61, s33
    s_mov_b32 s62, 19922944
    s_mov_b32 s63, 0x20000
    s_mov_b32 s64, s28
    s_mov_b32 s65, s29
    s_mov_b32 s66, 4194304
    s_mov_b32 s67, 0x20000
    s_bitcmp1_b32 s70, 0
    s_cselect_b32 s48, s16, s14
    s_cselect_b32 s49, s17, s15
    s_mov_b32 s50, 524288
    s_mov_b32 s51, 0x20000
    s_lshl_b32 s3, s75, 7
    s_lshl_b32 s34, s74, 6
    s_add_u32 s3, s3, s34
    v_lshl_add_u32 v92, v81, 1, s3
    global_load_ushort v42, v92, s[20:21]
    s_mul_i32 s34, s74, 22
    s_add_u32 s34, s34, s75
    s_mul_i32 s35, s74, 21
    s_add_u32 s35, s35, 5
    s_min_u32 s35, s35, s34
    s_sub_u32 s35, s35, s34
    s_lshl_b32 s35, s35, 6
    s_add_u32 s2, s35, 1024
    s_lshl_b32 s34, s34, 6
    s_mul_i32 s0, s76, 176128
    s_xor_b32 s35, s76, 1
    s_mul_i32 s1, s35, 176128
    s_add_u32 s0, s0, s34
    s_add_u32 s1, s1, s34
    s_lshl_b32 s34, s70, 1
    s_xor_b32 s34, s34, s75
    s_lshl_b32 s76, s34, 15
    s_lshr_b32 s34, s75, 1
    s_lshr_b32 s35, s70, 1
    s_xor_b32 s34, s34, s35
    s_lshl_b32 s34, s34, 7
    s_lshl_b32 s35, s75, 16
    s_add_u32 s34, s34, s35
    s_mul_i32 s35, s74, 33280
    s_add_u32 s4, s34, s35
    s_lshl_b32 s3, s73, 1
    s_add_u32 s3, s3, s74
    s_mul_i32 s5, s3, 98304
    s_add_u32 s5, s5, 6815744
    s_lshl_b32 s3, s3, 7
    s_add_u32 s3, s3, 262144
    s_lshl_b32 s34, s75, 2
    s_add_u32 s6, s3, s34
    v_lshl_add_u32 v40, v81, 2, s3
    s_mov_b32 s10, 0
    s_mov_b32 s11, -1
    s_mov_b32 s8, 0xffff0000
    s_mov_b32 s9, 0xffff0000
    s_bitcmp1_b32 s70, 0
    s_cselect_b64 s[12:13], -1, 0
    s_bitcmp1_b32 s70, 1
    s_cselect_b64 s[14:15], -1, 0
    v_lshlrev_b32 v31, 4, v1
    v_lshrrev_b32 v88, 2, v1
    v_mul_u32_u24 v88, 2752, v88
    v_and_b32 v89, 3, v1
    v_lshl_add_u32 v10, v89, 4, v88
    v_add_u32 v11, 43008, v10
    v_add_u32 v12, 86016, v10
    v_add_u32 v13, 129024, v10
    v_bfe_u32 v90, v1, 2, 2
    v_bfe_u32 v92, v1, 1, 3
    v_xor_b32 v92, v92, v82
    v_lshlrev_b32 v18, 7, v81
    v_lshl_add_u32 v18, v92, 4, v18
    v_add_u32 v18, s77, v18
    v_xor_b32 v19, 32, v18
    v_xor_b32 v20, 64, v18
    v_xor_b32 v21, 96, v18
    v_add_u32 v22, 98304, v18
    v_add_u32 v26, 65536, v18
    v_add_u32 v23, 98304, v19
    v_add_u32 v27, 65536, v19
    v_add_u32 v24, 98304, v20
    v_add_u32 v28, 65536, v20
    v_add_u32 v25, 98304, v21
    v_add_u32 v29, 65536, v21
    s_add_u32 s3, s77, 65536
    v_lshlrev_b32 v32, 6, v81
    v_lshl_add_u32 v32, v92, 3, v32
    v_add_u32 v32, s3, v32
    v_lshl_add_u32 v93, v82, 3, v90
    v_and_b32 v94, 1, v1
    v_bfe_u32 v95, v1, 1, 1
    v_lshl_add_u32 v94, v94, 1, v95
    v_lshlrev_b32 v94, 3, v94
    v_lshl_add_u32 v94, v91, 5, v94
    v_lshl_add_u32 v30, v93, 6, v94
    s_add_u32 s34, s77, 131072
    v_add_u32 v30, s34, v30
    v_bfe_u32 v95, v1, 3, 1
    v_lshl_add_u32 v94, v91, 2, v89
    v_lshl_add_u32 v95, v82, 2, v95
    v_xor_b32 v94, v94, v95
    v_lshlrev_b32 v94, 3, v94
    v_lshl_add_u32 v94, v93, 6, v94
    v_add_u32 v34, s3, v94
    v_xor_b32 v94, 16, v94
    v_add_u32 v94, 256, v94
    v_add_u32 v35, s3, v94
    v_and_b32 v94, 7, v1
    v_lshlrev_b32 v95, 2, v91
    v_xor_b32 v94, v94, v95
    v_lshlrev_b32 v94, 4, v94
    v_lshl_add_u32 v14, v83, 10, v94
    s_mul_i32 s3, s74, 720896
    s_lshl_b32 s34, s75, 7
    s_add_u32 s3, s3, s34
    v_add_u32 v14, s3, v14
    v_add_u32 v15, 7168, v14
    v_add_u32 v16, 14336, v14
    v_add_u32 v17, 21504, v14
    v_lshlrev_b32 v37, 4, v81
    v_add_u32 v37, 86016, v37
    s_lshl_b32 s3, s70, 2
    v_add_u32 v36, s3, v37
    v_lshlrev_b32 v38, 3, v81
    v_add_u32 v38, 94208, v38
    s_lshl_b32 s3, s70, 8
    v_add_u32 v39, s3, v38
    s_add_u32 s3, s3, 96256
    v_lshl_add_u32 v41, v82, 4, s3
    v_and_b32 v94, 1, v1
    v_cmp_eq_u32 vcc, v94, v91
    v_mov_b32 v95, 0x3f803f80
    s_nop 0
    v_cndmask_b32 v196, 0, v95, vcc
    v_mov_b32 v197, v196
    v_mov_b32 v198, v196
    v_mov_b32 v199, v196
    v_mov_b32 v185, 0
    v_mov_b32 v186, 0
    v_mov_b32 v187, 0
    v_mov_b32 v189, 0
    v_mov_b32 v190, 0
    v_mov_b32 v191, 0
    v_mov_b32 v193, 0
    v_mov_b32 v194, 0
    v_mov_b32 v195, 0
    v_lshlrev_b32 v96, 4, v85
    v_bfe_u32 v94, v1, 2, 1
    v_lshlrev_b32 v94, 4, v94
    v_and_b32 v95, 1, v1
    v_lshl_add_u32 v94, v95, 3, v94
    v_lshl_add_u32 v94, v91, 2, v94
    v_bfe_u32 v95, v1, 3, 1
    v_lshl_add_u32 v94, v95, 1, v94
    v_bfe_u32 v95, v1, 1, 1
    v_add_u32 v94, v95, v94
    v_lshlrev_b32 v97, 4, v94
    v_lshl_add_u32 v98, v81, 2, s3
    s_waitcnt vmcnt(16)
    s_add_u32 m0, s77, 4096
    s_nop 0
    buffer_load_dwordx4 v2, s[40:43], s31 offen lds
    buffer_load_dwordx4 v3, s[40:43], s31 offen offset:1024 lds
    buffer_load_dwordx4 v4, s[40:43], s31 offen offset:2048 lds
    buffer_load_dwordx4 v5, s[40:43], s31 offen offset:3072 lds
    v_lshlrev_b32 v80, 16, v144
    v_and_b32 v81, 0xffff0000, v144
    v_lshlrev_b32 v82, 16, v145
    v_and_b32 v83, 0xffff0000, v145
    v_lshlrev_b32 v84, 16, v146
    v_and_b32 v85, 0xffff0000, v146
    v_lshlrev_b32 v86, 16, v147
    v_and_b32 v87, 0xffff0000, v147
    v_lshlrev_b32 v88, 16, v148
    v_and_b32 v89, 0xffff0000, v148
    v_lshlrev_b32 v90, 16, v149
    v_and_b32 v91, 0xffff0000, v149
    v_lshlrev_b32 v92, 16, v150
    v_and_b32 v93, 0xffff0000, v150
    v_lshlrev_b32 v94, 16, v151
    v_and_b32 v95, 0xffff0000, v151
    v_pk_add_f32 v[160:161], v[80:81], v[82:83]
    v_pk_add_f32 v[162:163], v[84:85], v[86:87]
    v_pk_add_f32 v[164:165], v[88:89], v[90:91]
    v_pk_add_f32 v[166:167], v[92:93], v[94:95]
    v_pk_add_f32 v[160:161], v[160:161], v[162:163]
    v_pk_add_f32 v[164:165], v[164:165], v[166:167]
    v_pk_add_f32 v[160:161], v[160:161], v[164:165]
    v_add_f32 v160, v160, v161
    s_nop 1
    v_add_f32_dpp v160, v160, v160 quad_perm:[1,0,3,2] row_mask:0xf bank_mask:0xf
    s_nop 1
    v_add_f32_dpp v160, v160, v160 quad_perm:[2,3,0,1] row_mask:0xf bank_mask:0xf
    s_nop 1
    v_add_f32_dpp v160, v160, v160 row_half_mirror row_mask:0xf bank_mask:0xf
    s_nop 1
    v_add_f32_dpp v160, v160, v160 row_mirror row_mask:0xf bank_mask:0xf
    v_mov_b32 v161, v160
    s_nop 1
    v_permlane16_swap_b32 v160, v161
    v_add_f32 v160, v160, v161
    v_mul_f32 v160, 0x3b000000, v160
    s_add_u32 m0, s77, 36864
    s_nop 0
    buffer_load_dwordx4 v2, s[44:47], s31 offen lds
    buffer_load_dwordx4 v3, s[44:47], s31 offen offset:1024 lds
    buffer_load_dwordx4 v4, s[44:47], s31 offen offset:2048 lds
    buffer_load_dwordx4 v5, s[44:47], s31 offen offset:3072 lds
    v_pk_add_f32 v[80:81], v[80:81], v[160:161] op_sel_hi:[1,0] neg_lo:[0,1] neg_hi:[0,1]
    v_pk_add_f32 v[82:83], v[82:83], v[160:161] op_sel_hi:[1,0] neg_lo:[0,1] neg_hi:[0,1]
    v_pk_add_f32 v[84:85], v[84:85], v[160:161] op_sel_hi:[1,0] neg_lo:[0,1] neg_hi:[0,1]
    v_pk_add_f32 v[86:87], v[86:87], v[160:161] op_sel_hi:[1,0] neg_lo:[0,1] neg_hi:[0,1]
    v_pk_add_f32 v[88:89], v[88:89], v[160:161] op_sel_hi:[1,0] neg_lo:[0,1] neg_hi:[0,1]
    v_pk_add_f32 v[90:91], v[90:91], v[160:161] op_sel_hi:[1,0] neg_lo:[0,1] neg_hi:[0,1]
    v_pk_add_f32 v[92:93], v[92:93], v[160:161] op_sel_hi:[1,0] neg_lo:[0,1] neg_hi:[0,1]
    v_pk_add_f32 v[94:95], v[94:95], v[160:161] op_sel_hi:[1,0] neg_lo:[0,1] neg_hi:[0,1]
    v_pk_mul_f32 v[162:163], v[80:81], v[80:81]
    v_pk_mul_f32 v[164:165], v[82:83], v[82:83]
    v_pk_fma_f32 v[162:163], v[84:85], v[84:85], v[162:163]
    v_pk_fma_f32 v[164:165], v[86:87], v[86:87], v[164:165]
    v_pk_fma_f32 v[162:163], v[88:89], v[88:89], v[162:163]
    v_pk_fma_f32 v[164:165], v[90:91], v[90:91], v[164:165]
    v_pk_fma_f32 v[162:163], v[92:93], v[92:93], v[162:163]
    v_pk_fma_f32 v[164:165], v[94:95], v[94:95], v[164:165]
    v_pk_add_f32 v[162:163], v[162:163], v[164:165]
    v_add_f32 v162, v162, v163
    s_nop 1
    v_add_f32_dpp v162, v162, v162 quad_perm:[1,0,3,2] row_mask:0xf bank_mask:0xf
    s_nop 1
    v_add_f32_dpp v162, v162, v162 quad_perm:[2,3,0,1] row_mask:0xf bank_mask:0xf
    s_nop 1
    v_add_f32_dpp v162, v162, v162 row_half_mirror row_mask:0xf bank_mask:0xf
    s_nop 1
    v_add_f32_dpp v162, v162, v162 row_mirror row_mask:0xf bank_mask:0xf
    v_mov_b32 v163, v162
    s_nop 1
    v_permlane16_swap_b32 v162, v163
    v_add_f32 v162, v162, v163
    v_mul_f32 v162, 0x3b000000, v162
    v_cvt_pk_bf16_f32 v164, v160, v162
    v_lshlrev_b32 v44, 16, v164
    v_and_b32 v165, 0xffff0000, v164
    v_add_f32 v165, 0x3727c5ac, v165
    v_cvt_pk_bf16_f32 v165, v165, v165
    v_and_b32 v165, 0xffff0000, v165
    v_sqrt_f32 v165, v165
    s_nop 0
    v_cvt_pk_bf16_f32 v165, v165, v165
    v_and_b32 v165, 0xffff0000, v165
    v_rcp_f32 v46, v165
    s_waitcnt lgkmcnt(0)
    s_mul_i32 s71, s71, 0x19660d
    s_add_u32 s71, s71, 0x3c6ef35f
    v_mov_b32 v43, s71
    v_mov_b32 v45, s71
    v_mov_b32 v47, s71
    s_mov_b32 s32, s71
    s_mov_b32 s33, s71
    s_mov_b32 exec_lo, 1
    s_mov_b32 exec_hi, 1
    buffer_store_dwordx4 v[44:47], v96, s[60:63], 0 offen sc1
    s_mov_b64 exec, -1
    s_xor_b32 s34, s78, 128
    s_add_u32 m0, s77, 102400
    s_nop 0
    buffer_load_dwordx4 v6, s[36:39], s34 offen lds
    buffer_load_dwordx4 v7, s[36:39], s34 offen offset:1024 lds
    buffer_load_dwordx4 v8, s[36:39], s34 offen offset:2048 lds
    buffer_load_dwordx4 v9, s[36:39], s34 offen offset:3072 lds
    s_xor_b32 s34, s78, 256
    s_add_u32 m0, s77, 131072
    s_nop 0
    buffer_load_dwordx4 v6, s[36:39], s34 offen lds
    buffer_load_dwordx4 v7, s[36:39], s34 offen offset:1024 lds
    buffer_load_dwordx4 v8, s[36:39], s34 offen offset:2048 lds
    buffer_load_dwordx4 v9, s[36:39], s34 offen offset:3072 lds
    s_waitcnt vmcnt(30)
    v_lshlrev_b32 v234, 16, v234
    v_lshlrev_b32 v235, 16, v235
    v_lshlrev_b32 v236, 16, v236
    v_mul_f32 v236, 0x3fb8aa3b, v236
    v_exp_f32 v236, v236
    s_nop 0
    v_cvt_pk_bf16_f32 v236, v236, v236
    v_and_b32 v236, 0xffff0000, v236
    v_mul_f32 v238, v236, v234
    v_mul_f32 v239, v236, v235
    v_mul_f32 v238, 0x3fb8aa3b, v238
    v_mul_f32 v239, 0.15915494, v239
    v_exp_f32 v238, v238
    v_fract_f32 v239, v239
    v_cos_f32 v240, v239
    v_sin_f32 v241, v239
    v_mul_f32 v242, v234, v234
    v_fma_f32 v242, v235, v235, v242
    v_mul_f32 v200, v238, v240
    v_mul_f32 v201, v238, v241
    v_rcp_f32 v242, v242
    v_add_f32 v243, -1.0, v200
    v_add_f32 v242, v242, v242
    v_mul_f32 v208, v243, v234
    v_mul_f32 v209, v201, v234
    v_fma_f32 v208, v201, v235, v208
    v_fma_f32 v209, -v243, v235, v209
    v_mul_f32 v208, v208, v242
    v_mul_f32 v209, v209, v242
    v_mul_f32 v234, v200, v200
    v_mul_f32 v235, v200, v201
    v_fma_f32 v234, -v201, v201, v234
    v_fma_f32 v235, v201, v200, v235
    v_mul_f32 v236, v234, v234
    v_mul_f32 v237, v234, v235
    v_fma_f32 v236, -v235, v235, v236
    v_fma_f32 v237, v235, v234, v237
    v_mul_f32 v202, v236, v236
    v_mul_f32 v203, v236, v237
    v_fma_f32 v202, -v237, v237, v202
    v_fma_f32 v203, v237, v236, v203
    v_mul_f32 v204, v202, v202
    v_mul_f32 v205, v202, v203
    v_fma_f32 v204, -v203, v203, v204
    v_fma_f32 v205, v203, v202, v205
    v_mul_f32 v206, v204, v204
    v_mul_f32 v207, v204, v205
    v_fma_f32 v206, -v205, v205, v206
    v_fma_f32 v207, v205, v204, v207
    s_waitcnt vmcnt(22)
    s_waitcnt vmcnt(18)
    ds_read_b128 a[0:3], v22 offset:0
    ds_read_b128 a[4:7], v23 offset:0
    ds_read_b128 a[8:11], v24 offset:0
    ds_read_b128 a[12:15], v25 offset:0
    ds_read_b128 v[112:115], v18 offset:0
    ds_read_b128 v[116:119], v18 offset:32768
    ds_read_b128 v[120:123], v19 offset:0
    ds_read_b128 v[124:127], v19 offset:32768
    ds_read_b128 v[128:131], v20 offset:0
    ds_read_b128 v[132:135], v20 offset:32768
    ds_read_b128 v[136:139], v21 offset:0
    ds_read_b128 v[140:143], v21 offset:32768
    s_waitcnt lgkmcnt(6)
    v_mfma_f32_32x32x16_bf16 v[48:63], a[0:3], v[112:115], 0
    s_xor_b32 s34, s78, 384
    s_add_u32 m0, s77, 135168
    s_nop 0
    buffer_load_dwordx4 v6, s[36:39], s34 offen lds
    buffer_load_dwordx4 v7, s[36:39], s34 offen offset:1024 lds
    v_mul_f32 v238, v206, v206
    v_mfma_f32_16x16x32_bf16 v[176:179], v[196:199], v[112:115], 0
    v_mul_f32 v239, v206, v207
    v_fma_f32 v238, -v207, v207, v238
    v_fma_f32 v239, v207, v206, v239
    v_mfma_f32_32x32x16_bf16 v[64:79], a[0:3], v[116:119], 0
    v_mul_f32 v240, v238, v238
    v_mul_f32 v241, v238, v239
    v_fma_f32 v240, -v239, v239, v240
    v_fma_f32 v241, v239, v238, v241
    v_cndmask_b32 v234, 1.0, v204, s[10:11]
    v_mfma_f32_16x16x32_bf16 v[180:183], v[196:199], v[116:119], 0
    buffer_load_dwordx4 v8, s[36:39], s34 offen offset:2048 lds
    v_cndmask_b32 v235, 0, v205, s[10:11]
    v_cndmask_b32 v236, 1.0, v206, s[12:13]
    s_waitcnt lgkmcnt(4)
    v_mfma_f32_32x32x16_bf16 v[48:63], a[4:7], v[120:123], v[48:63]
    v_cndmask_b32 v237, 0, v207, s[12:13]
    v_cndmask_b32 v242, 1.0, v238, s[14:15]
    v_cndmask_b32 v243, 0, v239, s[14:15]
    v_mul_f32 v244, v234, v236
    v_mul_f32 v245, v234, v237
    v_mfma_f32_16x16x32_bf16 v[176:179], v[196:199], v[120:123], v[176:179]
    v_fma_f32 v244, -v235, v237, v244
    v_fma_f32 v245, v235, v236, v245
    v_mul_f32 v234, v244, v242
    v_mfma_f32_32x32x16_bf16 v[64:79], a[4:7], v[124:127], v[64:79]
    buffer_load_dwordx4 v9, s[36:39], s34 offen offset:3072 lds
    s_xor_b32 s34, s78, 512
    s_add_u32 m0, s77, 65536
    v_mul_f32 v235, v244, v243
    v_fma_f32 v234, -v245, v243, v234
    v_mfma_f32_16x16x32_bf16 v[180:183], v[196:199], v[124:127], v[180:183]
    v_fma_f32 v235, v245, v242, v235
    v_mul_f32 v236, v234, v202
    v_mul_f32 v237, v234, v203
    s_waitcnt lgkmcnt(2)
    v_mfma_f32_32x32x16_bf16 v[48:63], a[8:11], v[128:131], v[48:63]
    buffer_load_dwordx4 v6, s[36:39], s34 offen lds
    v_fma_f32 v236, -v235, v203, v236
    v_fma_f32 v237, v235, v202, v237
    v_mov_b32 v226, v234
    v_mov_b32 v227, v236
    v_mfma_f32_16x16x32_bf16 v[176:179], v[196:199], v[128:131], v[176:179]
    v_mov_b32 v228, v235
    v_mov_b32 v229, v237
    v_mul_f32 v236, v234, v234
    v_mfma_f32_32x32x16_bf16 v[64:79], a[8:11], v[132:135], v[64:79]
    v_mul_f32 v237, v234, v235
    v_fma_f32 v236, -v235, v235, v236
    v_fma_f32 v237, v235, v234, v237
    v_mul_f32 v234, v236, v236
    v_mul_f32 v235, v236, v237
    v_mfma_f32_16x16x32_bf16 v[180:183], v[196:199], v[132:135], v[180:183]
    buffer_load_dwordx4 v7, s[36:39], s34 offen offset:1024 lds
    v_fma_f32 v234, -v237, v237, v234
    v_fma_f32 v235, v237, v236, v235
    s_waitcnt lgkmcnt(0)
    v_mfma_f32_32x32x16_bf16 v[48:63], a[12:15], v[136:139], v[48:63]
    v_mul_f32 v236, v234, v234
    v_mul_f32 v237, v234, v235
    v_fma_f32 v236, -v235, v235, v236
    v_fma_f32 v237, v235, v234, v237
    v_mul_f32 v230, v236, v236
    v_mfma_f32_16x16x32_bf16 v[176:179], v[196:199], v[136:139], v[176:179]
    v_mul_f32 v231, v236, v237
    v_fma_f32 v230, -v237, v237, v230
    v_fma_f32 v231, v237, v236, v231
    v_mfma_f32_32x32x16_bf16 v[64:79], a[12:15], v[140:143], v[64:79]
    buffer_load_dwordx4 v8, s[36:39], s34 offen offset:2048 lds
    v_mul_f32 v232, v230, v240
    v_mul_f32 v233, v230, v241
    v_fma_f32 v232, -v231, v241, v232
    v_fma_f32 v233, v231, v240, v233
    v_mfma_f32_16x16x32_bf16 v[180:183], v[196:199], v[140:143], v[180:183]
    buffer_load_dwordx4 v9, s[36:39], s34 offen offset:3072 lds
    s_waitcnt vmcnt(17)
    s_waitcnt vmcnt(12)
    ds_read_b128 a[16:19], v22 offset:4096
    ds_read_b128 a[20:23], v23 offset:4096
    ds_read_b128 a[24:27], v24 offset:4096
    ds_read_b128 a[28:31], v25 offset:4096
    ds_read_b128 v[112:115], v18 offset:4096
    ds_read_b128 v[116:119], v18 offset:36864
    ds_read_b128 v[120:123], v19 offset:4096
    ds_read_b128 v[124:127], v19 offset:36864
    ds_read_b128 v[128:131], v20 offset:4096
    ds_read_b128 v[132:135], v20 offset:36864
    ds_read_b128 v[136:139], v21 offset:4096
    ds_read_b128 v[140:143], v21 offset:36864
    s_waitcnt lgkmcnt(6)
    v_mfma_f32_32x32x16_bf16 v[48:63], a[16:19], v[112:115], v[48:63]
    s_and_b32 s35, s68, 3
    v_mfma_f32_16x16x32_bf16 v[176:179], v[196:199], v[112:115], v[176:179]
    s_lshl_b32 s35, s35, 3
    s_add_u32 s35, s35, s75
    s_lshl_b32 s35, s35, 2
    v_mfma_f32_32x32x16_bf16 v[64:79], a[16:19], v[116:119], v[64:79]
    s_add_u32 s35, s35, s70
    v_bfe_u32 v168, v1, 3, 1
    v_lshl_add_u32 v168, s35, 1, v168
    v_lshlrev_b32 v168, 10, v168
    v_and_b32 v169, 7, v1
    v_mfma_f32_16x16x32_bf16 v[180:183], v[196:199], v[116:119], v[180:183]
    v_lshl_add_u32 v168, v169, 7, v168
    v_lshrrev_b32 v169, 4, v1
    v_min_u32 v169, 1, v169
    s_waitcnt lgkmcnt(4)
    v_mfma_f32_32x32x16_bf16 v[48:63], a[20:23], v[120:123], v[48:63]
    v_lshl_add_u32 v168, v169, 18, v168
    s_mul_i32 s34, s74, 720896
    s_add_u32 s34, s34, 262144
    buffer_load_dword a255, v168, s[56:59], s34 offen
    v_mfma_f32_16x16x32_bf16 v[176:179], v[196:199], v[120:123], v[176:179]
    s_xor_b32 s34, s78, 640
    s_add_u32 m0, s77, 98304
    v_mul_f32 v210, v208, v200
    v_mfma_f32_32x32x16_bf16 v[64:79], a[20:23], v[124:127], v[64:79]
    v_mul_f32 v211, v208, v201
    v_fma_f32 v210, -v209, v201, v210
    v_fma_f32 v211, v209, v200, v211
    v_mul_f32 v212, v210, v200
    v_mul_f32 v213, v210, v201
    v_mfma_f32_16x16x32_bf16 v[180:183], v[196:199], v[124:127], v[180:183]
    v_fma_f32 v212, -v211, v201, v212
    v_fma_f32 v213, v211, v200, v213
    v_mul_f32 v214, v212, v200
    s_waitcnt lgkmcnt(3)
    v_mfma_f32_16x16x32_bf16 v[176:179], v[196:199], v[128:131], v[176:179]
    v_mul_f32 v215, v212, v201
    v_fma_f32 v214, -v213, v201, v214
    v_fma_f32 v215, v213, v200, v215
    s_waitcnt lgkmcnt(2)
    v_mfma_f32_16x16x32_bf16 v[180:183], v[196:199], v[132:135], v[180:183]
    v_mul_f32 v216, v214, v200
    v_mul_f32 v217, v214, v201
    v_fma_f32 v216, -v215, v201, v216
    s_waitcnt lgkmcnt(1)
    v_mfma_f32_16x16x32_bf16 v[176:179], v[196:199], v[136:139], v[176:179]
    v_fma_f32 v217, v215, v200, v217
    v_mul_f32 v218, v216, v200
    v_mul_f32 v219, v216, v201
    s_waitcnt lgkmcnt(0)
    v_mfma_f32_16x16x32_bf16 v[180:183], v[196:199], v[140:143], v[180:183]
    v_fma_f32 v218, -v217, v201, v218
    v_fma_f32 v219, v217, v200, v219
    v_mul_f32 v220, v218, v200
    v_mfma_f32_32x32x16_bf16 v[48:63], a[24:27], v[128:131], v[48:63]
    v_mul_f32 v221, v218, v201
    v_fma_f32 v220, -v219, v201, v220
    v_fma_f32 v221, v219, v200, v221
    v_mul_f32 v222, v220, v200
    v_mul_f32 v223, v220, v201
    v_mfma_f32_32x32x16_bf16 v[64:79], a[24:27], v[132:135], v[64:79]
    buffer_load_dwordx4 v6, s[36:39], s34 offen lds
    buffer_load_dwordx4 v7, s[36:39], s34 offen offset:1024 lds
    buffer_load_dwordx4 v8, s[36:39], s34 offen offset:2048 lds
    buffer_load_dwordx4 v9, s[36:39], s34 offen offset:3072 lds
    s_xor_b32 s34, s78, 768
    s_add_u32 m0, s77, 102400
    s_nop 0
    buffer_load_dwordx4 v6, s[36:39], s34 offen lds
    buffer_load_dwordx4 v7, s[36:39], s34 offen offset:1024 lds
    buffer_load_dwordx4 v8, s[36:39], s34 offen offset:2048 lds
    buffer_load_dwordx4 v9, s[36:39], s34 offen offset:3072 lds
    v_cndmask_b32 v176, v176, v177, s[8:9]
    ds_write_b32 v36, v176 offset:0
    v_cndmask_b32 v180, v180, v181, s[8:9]
    ds_write_b32 v36, v180 offset:512
    s_waitcnt lgkmcnt(0)
    s_barrier
    v_xor_b32 v18, 8192, v18
    v_xor_b32 v19, 8192, v19
    v_xor_b32 v20, 8192, v20
    v_xor_b32 v21, 8192, v21
    ds_read_b128 v[112:115], v18 offset:0
    ds_read_b128 v[116:119], v18 offset:32768
    ds_read_b128 v[120:123], v19 offset:0
    ds_read_b128 v[124:127], v19 offset:32768
    s_waitcnt vmcnt(17)
    ds_read_b128 a[32:35], v22 offset:32768
    ds_read_b128 a[36:39], v23 offset:32768
    ds_read_b128 a[40:43], v24 offset:32768
    ds_read_b128 a[44:47], v25 offset:32768
    ds_read_b128 v[128:131], v20 offset:0
    ds_read_b128 v[132:135], v20 offset:32768
    v_mfma_f32_32x32x16_bf16 v[48:63], a[28:31], v[136:139], v[48:63]
    v_fma_f32 v222, -v221, v201, v222
    v_mfma_f32_32x32x16_bf16 v[64:79], a[28:31], v[140:143], v[64:79]
    v_fma_f32 v223, v221, v200, v223
    v_mul_f32 v224, v222, v200
    v_mul_f32 v225, v222, v201
    v_fma_f32 v224, -v223, v201, v224
    v_fma_f32 v225, v223, v200, v225
    s_waitcnt lgkmcnt(5)
    v_mfma_f32_32x32x16_bf16 v[48:63], a[32:35], v[112:115], v[48:63]
    ds_read_b128 v[44:47], v37 offset:0
    v_mfma_f32_32x32x16_bf16 v[64:79], a[32:35], v[116:119], v[64:79]
    ds_read_b128 v[136:139], v21 offset:0
    ds_read_b128 v[140:143], v21 offset:32768
    s_waitcnt lgkmcnt(2)
    v_add_f32 v44, v44, v45
    v_add_f32 v46, v46, v47
    v_mfma_f32_32x32x16_bf16 v[48:63], a[36:39], v[120:123], v[48:63]
    v_add_f32 v44, v44, v46
    v_cvt_pk_bf16_f32 v45, v44, v44
    v_and_b32 v45, 0xffff0000, v45
    v_sub_f32 v44, v44, v45
    v_cvt_pk_bf16_f32 v188, v45, v44
    v_mfma_f32_32x32x16_bf16 v[64:79], a[36:39], v[124:127], v[64:79]
    ds_read_b128 v[112:115], v18 offset:4096
    ds_read_b128 v[116:119], v18 offset:36864
    ds_read_b128 v[44:47], v37 offset:512
    v_mfma_f32_32x32x16_bf16 v[48:63], a[40:43], v[128:131], v[48:63]
    s_waitcnt lgkmcnt(0)
    v_add_f32 v44, v44, v45
    v_add_f32 v46, v46, v47
    v_add_f32 v44, v44, v46
    v_cvt_pk_bf16_f32 v45, v44, v44
    v_mfma_f32_32x32x16_bf16 v[64:79], a[40:43], v[132:135], v[64:79]
    ds_read_b128 v[120:123], v19 offset:4096
    ds_read_b128 v[124:127], v19 offset:36864
    s_waitcnt vmcnt(13)
    ds_read_b128 a[48:51], v22 offset:36864
    ds_read_b128 a[52:55], v23 offset:36864
    ds_read_b128 a[56:59], v24 offset:36864
    ds_read_b128 a[60:63], v25 offset:36864
    v_mfma_f32_32x32x16_bf16 v[48:63], a[44:47], v[136:139], v[48:63]
    v_and_b32 v45, 0xffff0000, v45
    v_sub_f32 v44, v44, v45
    v_cvt_pk_bf16_f32 v192, v45, v44
    v_mfma_f32_32x32x16_bf16 v[64:79], a[44:47], v[140:143], v[64:79]
    ds_read_b128 v[128:131], v20 offset:4096
    ds_read_b128 v[132:135], v20 offset:36864
    s_waitcnt lgkmcnt(5)
    v_mfma_f32_32x32x16_bf16 v[48:63], a[48:51], v[112:115], v[48:63]
    v_mfma_f32_32x32x16_bf16 v[64:79], a[48:51], v[116:119], v[64:79]
    ds_read_b128 v[136:139], v21 offset:4096
    ds_read_b128 v[140:143], v21 offset:36864
    s_waitcnt lgkmcnt(6)
    v_mfma_f32_32x32x16_bf16 v[48:63], a[52:55], v[120:123], v[48:63]
    v_mfma_f32_32x32x16_bf16 v[64:79], a[52:55], v[124:127], v[64:79]
    v_xor_b32 v18, 24576, v18
    v_xor_b32 v19, 24576, v19
    v_xor_b32 v20, 24576, v20
    v_xor_b32 v21, 24576, v21
    ds_read_b128 v[112:115], v18 offset:0
    ds_read_b128 v[116:119], v18 offset:32768
    s_waitcnt lgkmcnt(4)
    v_mfma_f32_32x32x16_bf16 v[48:63], a[56:59], v[128:131], v[48:63]
    v_mfma_f32_32x32x16_bf16 v[64:79], a[56:59], v[132:135], v[64:79]
    ds_read_b128 v[120:123], v19 offset:0
    ds_read_b128 v[124:127], v19 offset:32768
    s_waitcnt vmcnt(9)
    ds_read_b128 a[64:67], v26 offset:0
    ds_read_b128 a[68:71], v27 offset:0
    ds_read_b128 a[72:75], v28 offset:0
    ds_read_b128 a[76:79], v29 offset:0
    s_waitcnt lgkmcnt(8)
    v_mfma_f32_32x32x16_bf16 v[48:63], a[60:63], v[136:139], v[48:63]
    v_mfma_f32_32x32x16_bf16 v[64:79], a[60:63], v[140:143], v[64:79]
    ds_read_b128 v[128:131], v20 offset:0
    ds_read_b128 v[132:135], v20 offset:32768
    s_waitcnt lgkmcnt(5)
    v_mfma_f32_32x32x16_bf16 v[48:63], a[64:67], v[112:115], v[48:63]
    s_waitcnt lgkmcnt(2)
    s_xor_b32 s34, s78, 896
    s_add_u32 m0, s77, 65536
    s_nop 0
    buffer_load_dwordx4 v6, s[36:39], s34 offen lds
    buffer_load_dwordx4 v7, s[36:39], s34 offen offset:1024 lds
    v_mfma_f32_32x32x16_bf16 v[64:79], a[64:67], v[116:119], v[64:79]
    ds_read_b128 v[136:139], v21 offset:0
    ds_read_b128 v[140:143], v21 offset:32768
    v_mfma_f32_32x32x16_bf16 v[48:63], a[68:71], v[120:123], v[48:63]
    buffer_load_dwordx4 v8, s[36:39], s34 offen offset:2048 lds
    v_mfma_f32_32x32x16_bf16 v[64:79], a[68:71], v[124:127], v[64:79]
    ds_read_b128 v[112:115], v18 offset:4096
    ds_read_b128 v[116:119], v18 offset:36864
    s_waitcnt lgkmcnt(4)
    v_mfma_f32_32x32x16_bf16 v[48:63], a[72:75], v[128:131], v[48:63]
    buffer_load_dwordx4 v9, s[36:39], s34 offen offset:3072 lds
    s_lshl_b32 s29, s73, 9
    v_mfma_f32_32x32x16_bf16 v[64:79], a[72:75], v[132:135], v[64:79]
    ds_read_b128 v[120:123], v19 offset:4096
    ds_read_b128 v[124:127], v19 offset:36864
    s_waitcnt vmcnt(8)
    ds_read_b128 a[80:83], v22 offset:0
    ds_read_b128 a[84:87], v23 offset:0
    ds_read_b128 a[88:91], v24 offset:0
    ds_read_b128 a[92:95], v25 offset:0
    s_waitcnt lgkmcnt(8)
    v_mfma_f32_32x32x16_bf16 v[48:63], a[76:79], v[136:139], v[48:63]
    buffer_load_dwordx4 v[44:47], v97, s[60:63], s29 offen sc1
    s_add_u32 m0, s77, 131072
    v_mfma_f32_32x32x16_bf16 v[64:79], a[76:79], v[140:143], v[64:79]
    ds_read_b128 v[128:131], v20 offset:4096
    ds_read_b128 v[132:135], v20 offset:36864
    s_waitcnt lgkmcnt(5)
    v_mfma_f32_32x32x16_bf16 v[48:63], a[80:83], v[112:115], v[48:63]
    buffer_load_dwordx4 v10, s[52:55], s0 offen lds
    v_mfma_f32_32x32x16_bf16 v[64:79], a[80:83], v[116:119], v[64:79]
    ds_read_b128 v[136:139], v21 offset:4096
    ds_read_b128 v[140:143], v21 offset:36864
    s_waitcnt lgkmcnt(6)
    v_mfma_f32_32x32x16_bf16 v[48:63], a[84:87], v[120:123], v[48:63]
    buffer_load_dwordx4 v11, s[52:55], s0 offen offset:1024 lds
    v_mfma_f32_32x32x16_bf16 v[64:79], a[84:87], v[124:127], v[64:79]
    v_xor_b32 v18, 8192, v18
    v_xor_b32 v19, 8192, v19
    v_xor_b32 v20, 8192, v20
    v_xor_b32 v21, 8192, v21
    ds_read_b128 v[112:115], v18 offset:0
    ds_read_b128 v[116:119], v18 offset:32768
    s_waitcnt lgkmcnt(4)
    v_mfma_f32_32x32x16_bf16 v[48:63], a[88:91], v[128:131], v[48:63]
    buffer_load_dwordx4 v12, s[52:55], s0 offen offset:2048 lds
    v_mfma_f32_32x32x16_bf16 v[64:79], a[88:91], v[132:135], v[64:79]
    ds_read_b128 v[120:123], v19 offset:0
    ds_read_b128 v[124:127], v19 offset:32768
    s_waitcnt vmcnt(8)
    ds_read_b128 a[96:99], v22 offset:4096
    ds_read_b128 a[100:103], v23 offset:4096
    ds_read_b128 a[104:107], v24 offset:4096
    ds_read_b128 a[108:111], v25 offset:4096
    s_waitcnt lgkmcnt(8)
    v_mfma_f32_32x32x16_bf16 v[48:63], a[92:95], v[136:139], v[48:63]
    buffer_load_dwordx4 v13, s[52:55], s0 offen offset:3072 lds
    s_add_u32 m0, s77, 135168
    v_mfma_f32_32x32x16_bf16 v[64:79], a[92:95], v[140:143], v[64:79]
    ds_read_b128 v[128:131], v20 offset:0
    ds_read_b128 v[132:135], v20 offset:32768
    s_waitcnt lgkmcnt(5)
    v_mfma_f32_32x32x16_bf16 v[48:63], a[96:99], v[112:115], v[48:63]
    buffer_load_dwordx4 v10, s[52:55], s1 offen lds
    v_mfma_f32_32x32x16_bf16 v[64:79], a[96:99], v[116:119], v[64:79]
    ds_read_b128 v[136:139], v21 offset:0
    ds_read_b128 v[140:143], v21 offset:32768
    s_waitcnt lgkmcnt(6)
    v_mfma_f32_32x32x16_bf16 v[48:63], a[100:103], v[120:123], v[48:63]
    buffer_load_dwordx4 v11, s[52:55], s1 offen offset:1024 lds
    v_mfma_f32_32x32x16_bf16 v[64:79], a[100:103], v[124:127], v[64:79]
    ds_read_b128 v[112:115], v18 offset:4096
    ds_read_b128 v[116:119], v18 offset:36864
    s_waitcnt lgkmcnt(4)
    v_mfma_f32_32x32x16_bf16 v[48:63], a[104:107], v[128:131], v[48:63]
    buffer_load_dwordx4 v12, s[52:55], s1 offen offset:2048 lds
    v_mfma_f32_32x32x16_bf16 v[64:79], a[104:107], v[132:135], v[64:79]
    ds_read_b128 v[120:123], v19 offset:4096
    ds_read_b128 v[124:127], v19 offset:36864
    s_waitcnt vmcnt(8)
    ds_read_b128 a[112:115], v26 offset:0
    ds_read_b128 a[116:119], v27 offset:0
    ds_read_b128 a[120:123], v28 offset:0
    ds_read_b128 a[124:127], v29 offset:0
    s_waitcnt lgkmcnt(8)
    v_mfma_f32_32x32x16_bf16 v[48:63], a[108:111], v[136:139], v[48:63]
    buffer_load_dwordx4 v13, s[52:55], s1 offen offset:3072 lds
    s_add_u32 s34, s0, 512
    v_mfma_f32_32x32x16_bf16 v[64:79], a[108:111], v[140:143], v[64:79]
    ds_read_b128 v[128:131], v20 offset:4096
    ds_read_b128 v[132:135], v20 offset:36864
    s_add_u32 m0, s77, 98304
    s_waitcnt vmcnt(8)
    s_waitcnt lgkmcnt(5)
    v_mfma_f32_32x32x16_bf16 v[48:63], a[112:115], v[112:115], v[48:63]
    buffer_load_dwordx4 v10, s[52:55], s34 offen lds
    v_cmp_ne_u32 s[22:23], s71, v45
    v_cmp_ne_u32 vcc, s71, v47
    s_or_b64 vcc, vcc, s[22:23]
    s_cbranch_scc0 Ldone1
Lretry1:
    s_cmp_eq_u32 s72, 0
    s_cbranch_scc1 Ldone1
    s_sub_u32 s72, s72, 1
    buffer_load_dwordx4 v[44:47], v97, s[60:63], s29 offen sc1
    s_waitcnt vmcnt(0)
    v_cmp_ne_u32 s[22:23], s71, v45
    v_cmp_ne_u32 vcc, s71, v47
    s_or_b64 vcc, vcc, s[22:23]
    s_cbranch_scc1 Lretry1
Ldone1:
    v_mfma_f32_32x32x16_bf16 v[64:79], a[112:115], v[116:119], v[64:79]
    ds_read_b128 v[136:139], v21 offset:4096
    ds_read_b128 v[140:143], v21 offset:36864
    ds_write2_b32 v98, v46, v44 offset0:0 offset1:32
    v_mov_b32 v0, v46
    v_cvt_pk_bf16_f32 v184, -v44, -v44
    s_waitcnt lgkmcnt(7)
    v_mfma_f32_32x32x16_bf16 v[48:63], a[116:119], v[120:123], v[48:63]
    buffer_load_dwordx4 v11, s[52:55], s34 offen offset:1024 lds
    v_cndmask_b32 v184, v184, 0, s[10:11]
    s_waitcnt lgkmcnt(0)
    ds_read_b128 v[96:99], v41 offset:0
    ds_read_b128 v[100:103], v41 offset:32
    v_mfma_f32_32x32x16_bf16 v[64:79], a[116:119], v[124:127], v[64:79]
    ds_read_b128 v[104:107], v41 offset:64
    ds_read_b128 v[108:111], v41 offset:96
    v_mfma_f32_32x32x16_bf16 v[48:63], a[120:123], v[128:131], v[48:63]
    buffer_load_dwordx4 v12, s[52:55], s34 offen offset:2048 lds
    v_mfma_f32_32x32x16_bf16 v[64:79], a[120:123], v[132:135], v[64:79]
    v_mfma_f32_32x32x16_bf16 v[48:63], a[124:127], v[136:139], v[48:63]
    buffer_load_dwordx4 v13, s[52:55], s34 offen offset:3072 lds
    s_add_u32 s34, s1, 512
    s_add_u32 m0, s77, 102400
    v_mfma_f32_32x32x16_bf16 v[64:79], a[124:127], v[140:143], v[64:79]
    v_mfma_f32_32x32x16_bf16 v[48:63], v[184:187], v[188:191], v[48:63]
    v_mfma_f32_32x32x16_bf16 v[64:79], v[184:187], v[192:195], v[64:79]
    v_lshrrev_b32 v8, 5, v1
    v_lshlrev_b32 v8, 1, v8
    s_lshl_b32 s3, s70, 2
    s_sub_u32 s3, s68, s3
    s_sub_u32 s3, s3, 1
    v_sub_u32 v8, s3, v8
    v_and_b32 v9, 31, v1
    v_lshlrev_b32 v9, 4, v9
    v_cmp_le_i32 s[16:17], 0, v8
    v_cmp_le_i32 s[18:19], 1, v8
    v_lshl_add_u32 v9, v8, 13, v9
    v_mov_b32 v8, 0x7ff00000
    v_add_u32 v7, -8192, v9
    v_cndmask_b32 v6, v8, v9, s[16:17]
    v_cndmask_b32 v7, v8, v7, s[18:19]
    s_waitcnt lgkmcnt(0)
    v_pk_mul_f32 v[48:49], v[48:49], v[96:97]
    v_pk_mul_f32 v[50:51], v[50:51], v[98:99]
    v_pk_mul_f32 v[52:53], v[52:53], v[100:101]
    v_pk_mul_f32 v[54:55], v[54:55], v[102:103]
    v_pk_mul_f32 v[56:57], v[56:57], v[104:105]
    v_pk_mul_f32 v[58:59], v[58:59], v[106:107]
    v_pk_mul_f32 v[60:61], v[60:61], v[108:109]
    v_pk_mul_f32 v[62:63], v[62:63], v[110:111]
    v_pk_mul_f32 v[64:65], v[64:65], v[96:97]
    v_pk_mul_f32 v[66:67], v[66:67], v[98:99]
    v_pk_mul_f32 v[68:69], v[68:69], v[100:101]
    v_pk_mul_f32 v[70:71], v[70:71], v[102:103]
    v_pk_mul_f32 v[72:73], v[72:73], v[104:105]
    v_pk_mul_f32 v[74:75], v[74:75], v[106:107]
    v_pk_mul_f32 v[76:77], v[76:77], v[108:109]
    v_pk_mul_f32 v[78:79], v[78:79], v[110:111]
    v_pk_fma_f32 v[50:51], v[200:201], v[48:49], v[50:51] op_sel_hi:[0,1,1]
    v_pk_fma_f32 v[66:67], v[200:201], v[64:65], v[66:67] op_sel_hi:[0,1,1]
    v_pk_fma_f32 v[50:51], v[200:201], v[64:65], v[50:51] op_sel:[1,0,0] op_sel_hi:[1,1,1] neg_lo:[1,0,0] neg_hi:[1,0,0]
    v_pk_fma_f32 v[66:67], v[200:201], v[48:49], v[66:67] op_sel:[1,0,0] op_sel_hi:[1,1,1]
    v_pk_fma_f32 v[52:53], v[200:201], v[50:51], v[52:53] op_sel_hi:[0,1,1]
    v_pk_fma_f32 v[68:69], v[200:201], v[66:67], v[68:69] op_sel_hi:[0,1,1]
    v_pk_fma_f32 v[52:53], v[200:201], v[66:67], v[52:53] op_sel:[1,0,0] op_sel_hi:[1,1,1] neg_lo:[1,0,0] neg_hi:[1,0,0]
    v_pk_fma_f32 v[68:69], v[200:201], v[50:51], v[68:69] op_sel:[1,0,0] op_sel_hi:[1,1,1]
    v_pk_fma_f32 v[54:55], v[200:201], v[52:53], v[54:55] op_sel_hi:[0,1,1]
    v_pk_fma_f32 v[70:71], v[200:201], v[68:69], v[70:71] op_sel_hi:[0,1,1]
    v_pk_fma_f32 v[54:55], v[200:201], v[68:69], v[54:55] op_sel:[1,0,0] op_sel_hi:[1,1,1] neg_lo:[1,0,0] neg_hi:[1,0,0]
    v_pk_fma_f32 v[70:71], v[200:201], v[52:53], v[70:71] op_sel:[1,0,0] op_sel_hi:[1,1,1]
    v_pk_fma_f32 v[56:57], v[200:201], v[54:55], v[56:57] op_sel_hi:[0,1,1]
    v_pk_fma_f32 v[72:73], v[200:201], v[70:71], v[72:73] op_sel_hi:[0,1,1]
    v_pk_fma_f32 v[56:57], v[200:201], v[70:71], v[56:57] op_sel:[1,0,0] op_sel_hi:[1,1,1] neg_lo:[1,0,0] neg_hi:[1,0,0]
    v_pk_fma_f32 v[72:73], v[200:201], v[54:55], v[72:73] op_sel:[1,0,0] op_sel_hi:[1,1,1]
    v_pk_fma_f32 v[58:59], v[200:201], v[56:57], v[58:59] op_sel_hi:[0,1,1]
    v_pk_fma_f32 v[74:75], v[200:201], v[72:73], v[74:75] op_sel_hi:[0,1,1]
    v_pk_fma_f32 v[58:59], v[200:201], v[72:73], v[58:59] op_sel:[1,0,0] op_sel_hi:[1,1,1] neg_lo:[1,0,0] neg_hi:[1,0,0]
    v_pk_fma_f32 v[74:75], v[200:201], v[56:57], v[74:75] op_sel:[1,0,0] op_sel_hi:[1,1,1]
    v_pk_fma_f32 v[60:61], v[200:201], v[58:59], v[60:61] op_sel_hi:[0,1,1]
    v_pk_fma_f32 v[76:77], v[200:201], v[74:75], v[76:77] op_sel_hi:[0,1,1]
    v_pk_fma_f32 v[60:61], v[200:201], v[74:75], v[60:61] op_sel:[1,0,0] op_sel_hi:[1,1,1] neg_lo:[1,0,0] neg_hi:[1,0,0]
    v_pk_fma_f32 v[76:77], v[200:201], v[58:59], v[76:77] op_sel:[1,0,0] op_sel_hi:[1,1,1]
    v_pk_fma_f32 v[62:63], v[200:201], v[60:61], v[62:63] op_sel_hi:[0,1,1]
    v_pk_fma_f32 v[78:79], v[200:201], v[76:77], v[78:79] op_sel_hi:[0,1,1]
    v_pk_fma_f32 v[62:63], v[200:201], v[76:77], v[62:63] op_sel:[1,0,0] op_sel_hi:[1,1,1] neg_lo:[1,0,0] neg_hi:[1,0,0]
    v_pk_fma_f32 v[78:79], v[200:201], v[60:61], v[78:79] op_sel:[1,0,0] op_sel_hi:[1,1,1]
    v_fma_f32 v234, v202, v62, v63
    v_fma_f32 v235, v202, v78, v79
    v_fma_f32 v234, -v203, v78, v234
    v_fma_f32 v235, v203, v62, v235
    v_mov_b32 v236, v234
    v_mov_b32 v237, v235
    s_nop 0
    v_permlane32_swap_b32 v234, v236
    v_permlane32_swap_b32 v235, v237
    v_fma_f32 v238, v204, v234, v236
    v_fma_f32 v239, v204, v235, v237
    v_fma_f32 v238, -v205, v235, v238
    v_fma_f32 v239, v205, v234, v239
    ds_write_b64 v39, v[238:239]
    s_waitcnt lgkmcnt(0)
    s_barrier
    ds_read2_b64 v[238:241], v38 offset0:0 offset1:32
    ds_read2_b64 v[242:245], v38 offset0:64 offset1:96
    s_lshl_b32 s20, s68, 4
    s_add_u32 s20, s20, s69
    s_lshl_b32 s20, s20, 9
    s_add_u32 s20, s20, 65536
    s_lshl_b32 s21, s70, 3
    v_mov_b32 v45, s71
    v_mov_b32 v47, s71
    s_waitcnt lgkmcnt(0)
    v_fma_f32 v250, v206, v238, v240
    v_fma_f32 v251, v206, v239, v241
    v_fma_f32 v250, -v207, v239, v250
    v_fma_f32 v251, v207, v238, v251
    v_fma_f32 v252, v206, v250, v242
    v_fma_f32 v253, v206, v251, v243
    v_fma_f32 v252, -v207, v251, v252
    v_fma_f32 v253, v207, v250, v253
    v_fma_f32 v254, v206, v252, v244
    v_fma_f32 v255, v206, v253, v245
    v_fma_f32 v254, -v207, v253, v254
    v_fma_f32 v255, v207, v252, v255
    v_mov_b32 v44, v254
    v_mov_b32 v46, v255
    s_lshl_b64 exec, 0xff, s21
    buffer_store_dwordx4 v[44:47], v31, s[60:63], s20 offen sc1
    s_mov_b64 exec, -1
    buffer_load_dwordx4 v10, s[52:55], s34 offen lds
    v_cndmask_b32 v240, 0, v238, s[12:13]
    v_cndmask_b32 v242, v250, v252, s[12:13]
    v_cndmask_b32 v238, v240, v242, s[14:15]
    v_cndmask_b32 v241, 0, v239, s[12:13]
    v_cndmask_b32 v243, v251, v253, s[12:13]
    v_cndmask_b32 v239, v241, v243, s[14:15]
    v_fma_f32 v240, v204, v238, v234
    v_fma_f32 v241, v204, v239, v235
    v_fma_f32 v240, -v205, v239, v240
    v_fma_f32 v241, v205, v238, v241
    v_cndmask_b32 v246, v238, v240, s[10:11]
    v_cndmask_b32 v248, v239, v241, s[10:11]
    v_fma_f32 v247, v202, v246, v62
    v_fma_f32 v249, v202, v248, v78
    v_fma_f32 v247, -v203, v248, v247
    v_fma_f32 v249, v203, v246, v249
    v_pk_mul_f32 v[144:145], v[208:209], v[48:49] op_sel_hi:[0,1]
    v_pk_fma_f32 v[144:145], v[208:209], v[64:65], v[144:145] op_sel:[1,0,0] op_sel_hi:[1,1,1] neg_lo:[1,0,0] neg_hi:[1,0,0]
    v_pk_mul_f32 v[64:65], v[208:209], v[64:65] op_sel_hi:[0,1] neg_lo:[1,0] neg_hi:[1,0]
    v_pk_fma_f32 v[64:65], v[208:209], v[48:49], v[64:65] op_sel:[1,0,0] op_sel_hi:[1,1,1] neg_lo:[1,0,0] neg_hi:[1,0,0]
    v_pk_mul_f32 v[146:147], v[208:209], v[50:51] op_sel_hi:[0,1]
    v_pk_fma_f32 v[146:147], v[208:209], v[66:67], v[146:147] op_sel:[1,0,0] op_sel_hi:[1,1,1] neg_lo:[1,0,0] neg_hi:[1,0,0]
    v_pk_mul_f32 v[66:67], v[208:209], v[66:67] op_sel_hi:[0,1] neg_lo:[1,0] neg_hi:[1,0]
    v_pk_fma_f32 v[66:67], v[208:209], v[50:51], v[66:67] op_sel:[1,0,0] op_sel_hi:[1,1,1] neg_lo:[1,0,0] neg_hi:[1,0,0]
    v_pk_mul_f32 v[148:149], v[208:209], v[52:53] op_sel_hi:[0,1]
    v_pk_fma_f32 v[148:149], v[208:209], v[68:69], v[148:149] op_sel:[1,0,0] op_sel_hi:[1,1,1] neg_lo:[1,0,0] neg_hi:[1,0,0]
    v_pk_mul_f32 v[68:69], v[208:209], v[68:69] op_sel_hi:[0,1] neg_lo:[1,0] neg_hi:[1,0]
    v_pk_fma_f32 v[68:69], v[208:209], v[52:53], v[68:69] op_sel:[1,0,0] op_sel_hi:[1,1,1] neg_lo:[1,0,0] neg_hi:[1,0,0]
    v_pk_mul_f32 v[150:151], v[208:209], v[54:55] op_sel_hi:[0,1]
    v_pk_fma_f32 v[150:151], v[208:209], v[70:71], v[150:151] op_sel:[1,0,0] op_sel_hi:[1,1,1] neg_lo:[1,0,0] neg_hi:[1,0,0]
    v_pk_mul_f32 v[70:71], v[208:209], v[70:71] op_sel_hi:[0,1] neg_lo:[1,0] neg_hi:[1,0]
    v_pk_fma_f32 v[70:71], v[208:209], v[54:55], v[70:71] op_sel:[1,0,0] op_sel_hi:[1,1,1] neg_lo:[1,0,0] neg_hi:[1,0,0]
    v_pk_mul_f32 v[152:153], v[208:209], v[56:57] op_sel_hi:[0,1]
    v_pk_fma_f32 v[152:153], v[208:209], v[72:73], v[152:153] op_sel:[1,0,0] op_sel_hi:[1,1,1] neg_lo:[1,0,0] neg_hi:[1,0,0]
    v_pk_mul_f32 v[72:73], v[208:209], v[72:73] op_sel_hi:[0,1] neg_lo:[1,0] neg_hi:[1,0]
    v_pk_fma_f32 v[72:73], v[208:209], v[56:57], v[72:73] op_sel:[1,0,0] op_sel_hi:[1,1,1] neg_lo:[1,0,0] neg_hi:[1,0,0]
    v_pk_mul_f32 v[154:155], v[208:209], v[58:59] op_sel_hi:[0,1]
    v_pk_fma_f32 v[154:155], v[208:209], v[74:75], v[154:155] op_sel:[1,0,0] op_sel_hi:[1,1,1] neg_lo:[1,0,0] neg_hi:[1,0,0]
    v_pk_mul_f32 v[74:75], v[208:209], v[74:75] op_sel_hi:[0,1] neg_lo:[1,0] neg_hi:[1,0]
    v_pk_fma_f32 v[74:75], v[208:209], v[58:59], v[74:75] op_sel:[1,0,0] op_sel_hi:[1,1,1] neg_lo:[1,0,0] neg_hi:[1,0,0]
    v_pk_mul_f32 v[156:157], v[208:209], v[60:61] op_sel_hi:[0,1]
    v_pk_fma_f32 v[156:157], v[208:209], v[76:77], v[156:157] op_sel:[1,0,0] op_sel_hi:[1,1,1] neg_lo:[1,0,0] neg_hi:[1,0,0]
    v_pk_mul_f32 v[76:77], v[208:209], v[76:77] op_sel_hi:[0,1] neg_lo:[1,0] neg_hi:[1,0]
    v_pk_fma_f32 v[76:77], v[208:209], v[60:61], v[76:77] op_sel:[1,0,0] op_sel_hi:[1,1,1] neg_lo:[1,0,0] neg_hi:[1,0,0]
    v_pk_mul_f32 v[158:159], v[208:209], v[62:63] op_sel_hi:[0,1]
    v_pk_fma_f32 v[158:159], v[208:209], v[78:79], v[158:159] op_sel:[1,0,0] op_sel_hi:[1,1,1] neg_lo:[1,0,0] neg_hi:[1,0,0]
    v_pk_mul_f32 v[78:79], v[208:209], v[78:79] op_sel_hi:[0,1] neg_lo:[1,0] neg_hi:[1,0]
    v_pk_fma_f32 v[78:79], v[208:209], v[62:63], v[78:79] op_sel:[1,0,0] op_sel_hi:[1,1,1] neg_lo:[1,0,0] neg_hi:[1,0,0]
    s_waitcnt vmcnt(10)
    ds_read_b64_tr_b16 v[112:113], v30 offset:0
    ds_read_b64_tr_b16 v[114:115], v30 offset:256
    ds_read_b64_tr_b16 v[116:117], v30 offset:1024
    ds_read_b64_tr_b16 v[118:119], v30 offset:1280
    ds_read_b64_tr_b16 v[120:121], v30 offset:2048
    ds_read_b64_tr_b16 v[122:123], v30 offset:2304
    ds_read_b64_tr_b16 v[124:125], v30 offset:3072
    ds_read_b64_tr_b16 v[126:127], v30 offset:3328
    s_waitcnt vmcnt(6)
    ds_read_b64_tr_b16 v[128:129], v30 offset:4096
    ds_read_b64_tr_b16 v[130:131], v30 offset:4352
    ds_read_b64_tr_b16 v[132:133], v30 offset:5120
    ds_read_b64_tr_b16 v[134:135], v30 offset:5376
    ds_read_b64_tr_b16 v[136:137], v30 offset:6144
    ds_read_b64_tr_b16 v[138:139], v30 offset:6400
    ds_read_b64_tr_b16 v[140:141], v30 offset:7168
    ds_read_b64_tr_b16 v[142:143], v30 offset:7424
    s_waitcnt lgkmcnt(12)
    v_mfma_f32_32x32x16_bf16 v[80:95], v[112:115], a[0:3], 0
    buffer_load_dwordx4 v11, s[52:55], s34 offen offset:1024 lds
    v_mfma_f32_16x16x32_bf16 v[176:179], v[196:199], v[112:115], 0
    v_mfma_f32_32x32x16_bf16 v[80:95], v[116:119], a[4:7], v[80:95]
    v_mfma_f32_16x16x32_bf16 v[176:179], v[196:199], v[116:119], v[176:179]
    buffer_load_dwordx4 v12, s[52:55], s34 offen offset:2048 lds
    s_waitcnt lgkmcnt(8)
    v_mfma_f32_32x32x16_bf16 v[80:95], v[120:123], a[8:11], v[80:95]
    v_mfma_f32_16x16x32_bf16 v[176:179], v[196:199], v[120:123], v[176:179]
    v_mfma_f32_32x32x16_bf16 v[80:95], v[124:127], a[12:15], v[80:95]
    buffer_load_dwordx4 v13, s[52:55], s34 offen offset:3072 lds
    s_xor_b32 s34, s76, 0
    s_add_u32 m0, s77, 32768
    v_mfma_f32_16x16x32_bf16 v[176:179], v[196:199], v[124:127], v[176:179]
    s_waitcnt lgkmcnt(6)
    v_mfma_f32_16x16x32_bf16 v[176:179], v[196:199], v[128:131], v[176:179]
    s_waitcnt lgkmcnt(4)
    v_mfma_f32_16x16x32_bf16 v[176:179], v[196:199], v[132:135], v[176:179]
    buffer_load_dwordx4 v14, s[56:59], s34 offen lds
    buffer_load_dwordx4 v15, s[56:59], s34 offen offset:1024 lds
    buffer_load_dwordx4 v16, s[56:59], s34 offen offset:2048 lds
    s_waitcnt lgkmcnt(2)
    v_mfma_f32_16x16x32_bf16 v[176:179], v[196:199], v[136:139], v[176:179]
    buffer_load_dwordx4 v17, s[56:59], s34 offen offset:3072 lds
    s_xor_b32 s34, s76, 32768
    s_add_u32 m0, s77, 36864
    s_waitcnt lgkmcnt(0)
    v_mfma_f32_16x16x32_bf16 v[176:179], v[196:199], v[140:143], v[176:179]
    buffer_load_dwordx4 v14, s[56:59], s34 offen lds
    buffer_load_dwordx4 v15, s[56:59], s34 offen offset:1024 lds
    v_mfma_f32_32x32x16_bf16 v[80:95], v[128:131], a[16:19], v[80:95]
    s_nop 8
    v_cndmask_b32 v176, v176, v177, s[8:9]
    ds_write_b32 v36, v176 offset:1024
    s_waitcnt lgkmcnt(0)
    s_barrier
    v_xor_b32 v30, 8192, v30
    ds_read_b64_tr_b16 v[112:113], v30 offset:0
    ds_read_b64_tr_b16 v[114:115], v30 offset:256
    ds_read_b64_tr_b16 v[116:117], v30 offset:1024
    ds_read_b64_tr_b16 v[118:119], v30 offset:1280
    ds_read_b64_tr_b16 v[120:121], v30 offset:2048
    ds_read_b64_tr_b16 v[122:123], v30 offset:2304
    ds_read_b64_tr_b16 v[124:125], v30 offset:3072
    ds_read_b64_tr_b16 v[126:127], v30 offset:3328
    v_mfma_f32_32x32x16_bf16 v[80:95], v[132:135], a[20:23], v[80:95]
    ds_read_b64_tr_b16 v[128:129], v30 offset:4096
    ds_read_b64_tr_b16 v[130:131], v30 offset:4352
    v_mfma_f32_32x32x16_bf16 v[80:95], v[136:139], a[24:27], v[80:95]
    ds_read_b64_tr_b16 v[132:133], v30 offset:5120
    ds_read_b64_tr_b16 v[134:135], v30 offset:5376
    buffer_load_dwordx4 v16, s[56:59], s34 offen offset:2048 lds
    v_mfma_f32_32x32x16_bf16 v[80:95], v[140:143], a[28:31], v[80:95]
    ds_read_b64_tr_b16 v[136:137], v30 offset:6144
    ds_read_b64_tr_b16 v[138:139], v30 offset:6400
    buffer_load_dwordx4 v17, s[56:59], s34 offen offset:3072 lds
    s_add_u32 s34, s0, s2
    s_waitcnt lgkmcnt(10)
    v_mfma_f32_32x32x16_bf16 v[80:95], v[112:115], a[32:35], v[80:95]
    ds_read_b64_tr_b16 v[140:141], v30 offset:7168
    ds_read_b64_tr_b16 v[142:143], v30 offset:7424
    s_add_u32 m0, s77, 0
    s_nop 0
    buffer_load_dwordx4 v10, s[52:55], s34 offen lds
    buffer_load_dwordx4 v11, s[52:55], s34 offen offset:1024 lds
    v_mfma_f32_32x32x16_bf16 v[80:95], v[116:119], a[36:39], v[80:95]
    v_xor_b32 v30, 24576, v30
    ds_read_b64_tr_b16 v[112:113], v30 offset:0
    ds_read_b64_tr_b16 v[114:115], v30 offset:256
    buffer_load_dwordx4 v12, s[52:55], s34 offen offset:2048 lds
    s_waitcnt lgkmcnt(10)
    v_mfma_f32_32x32x16_bf16 v[80:95], v[120:123], a[40:43], v[80:95]
    ds_read_b64_tr_b16 v[116:117], v30 offset:1024
    ds_read_b64_tr_b16 v[118:119], v30 offset:1280
    buffer_load_dwordx4 v13, s[52:55], s34 offen offset:3072 lds
    s_add_u32 s34, s1, s2
    s_add_u32 m0, s77, 4096
    v_mfma_f32_32x32x16_bf16 v[80:95], v[124:127], a[44:47], v[80:95]
    ds_read_b64_tr_b16 v[120:121], v30 offset:2048
    ds_read_b64_tr_b16 v[122:123], v30 offset:2304
    buffer_load_dwordx4 v10, s[52:55], s34 offen lds
    buffer_load_dwordx4 v11, s[52:55], s34 offen offset:1024 lds
    s_waitcnt lgkmcnt(10)
    v_mfma_f32_32x32x16_bf16 v[80:95], v[128:131], a[48:51], v[80:95]
    ds_read_b64_tr_b16 v[124:125], v30 offset:3072
    ds_read_b64_tr_b16 v[126:127], v30 offset:3328
    buffer_load_dwordx4 v12, s[52:55], s34 offen offset:2048 lds
    buffer_load_dwordx4 v13, s[52:55], s34 offen offset:3072 lds
    ds_read_b128 v[44:47], v37 offset:1024
    v_mfma_f32_32x32x16_bf16 v[80:95], v[132:135], a[52:55], v[80:95]
    ds_read_b64_tr_b16 v[128:129], v30 offset:4096
    ds_read_b64_tr_b16 v[130:131], v30 offset:4352
    s_waitcnt lgkmcnt(11)
    v_mfma_f32_32x32x16_bf16 v[80:95], v[136:139], a[56:59], v[80:95]
    ds_read_b64_tr_b16 v[132:133], v30 offset:5120
    ds_read_b64_tr_b16 v[134:135], v30 offset:5376
    s_waitcnt lgkmcnt(4)
    v_add_f32 v44, v44, v45
    v_add_f32 v46, v46, v47
    v_mfma_f32_32x32x16_bf16 v[80:95], v[140:143], a[60:63], v[80:95]
    ds_read_b64_tr_b16 v[136:137], v30 offset:6144
    ds_read_b64_tr_b16 v[138:139], v30 offset:6400
    v_add_f32 v44, v44, v46
    v_cvt_pk_bf16_f32 v45, v44, v44
    v_mfma_f32_32x32x16_bf16 v[80:95], v[112:115], a[64:67], v[80:95]
    ds_read_b64_tr_b16 v[140:141], v30 offset:7168
    ds_read_b64_tr_b16 v[142:143], v30 offset:7424
    v_and_b32 v45, 0xffff0000, v45
    v_sub_f32 v44, v44, v45
    v_cvt_pk_bf16_f32 v188, v45, v44
    v_mfma_f32_32x32x16_bf16 v[80:95], v[116:119], a[68:71], v[80:95]
    v_xor_b32 v30, 8192, v30
    ds_read_b64_tr_b16 v[112:113], v30 offset:0
    ds_read_b64_tr_b16 v[114:115], v30 offset:256
    s_and_b32 s20, s75, 1
    v_mfma_f32_32x32x16_bf16 v[80:95], v[120:123], a[72:75], v[80:95]
    ds_read_b64_tr_b16 v[116:117], v30 offset:1024
    ds_read_b64_tr_b16 v[118:119], v30 offset:1280
    s_lshl_b32 s20, s20, 6
    v_and_b32 v10, 0xfff, v18
    v_xor_b32 v10, s20, v10
    v_mfma_f32_32x32x16_bf16 v[80:95], v[124:127], a[76:79], v[80:95]
    ds_read_b64_tr_b16 v[120:121], v30 offset:2048
    ds_read_b64_tr_b16 v[122:123], v30 offset:2304
    v_add_u32 v18, 98304, v10
    v_and_b32 v11, 0xfff, v19
    s_waitcnt lgkmcnt(10)
    v_mfma_f32_32x32x16_bf16 v[80:95], v[128:131], a[80:83], v[80:95]
    ds_read_b64_tr_b16 v[124:125], v30 offset:3072
    ds_read_b64_tr_b16 v[126:127], v30 offset:3328
    v_xor_b32 v11, s20, v11
    v_add_u32 v19, 98304, v11
    v_and_b32 v12, 0xfff, v20
    v_mfma_f32_32x32x16_bf16 v[80:95], v[132:135], a[84:87], v[80:95]
    ds_read_b64_tr_b16 v[128:129], v30 offset:4096
    ds_read_b64_tr_b16 v[130:131], v30 offset:4352
    v_xor_b32 v12, s20, v12
    v_add_u32 v20, 98304, v12
    s_waitcnt lgkmcnt(10)
    v_mfma_f32_32x32x16_bf16 v[80:95], v[136:139], a[88:91], v[80:95]
    ds_read_b64_tr_b16 v[132:133], v30 offset:5120
    ds_read_b64_tr_b16 v[134:135], v30 offset:5376
    s_lshl_b32 s28, s69, 9
    s_add_u32 s28, s28, 65536
    buffer_load_dwordx4 v[238:241], v6, s[60:63], s28 offen sc1
    v_mfma_f32_32x32x16_bf16 v[80:95], v[140:143], a[92:95], v[80:95]
    ds_read_b64_tr_b16 v[136:137], v30 offset:6144
    ds_read_b64_tr_b16 v[138:139], v30 offset:6400
    buffer_load_dwordx4 v[242:245], v7, s[60:63], s28 offen sc1
    v_and_b32 v13, 0xfff, v21
    s_waitcnt lgkmcnt(10)
    v_mfma_f32_32x32x16_bf16 v[80:95], v[112:115], a[96:99], v[80:95]
    ds_read_b64_tr_b16 v[140:141], v30 offset:7168
    ds_read_b64_tr_b16 v[142:143], v30 offset:7424
    v_xor_b32 v13, s20, v13
    v_add_u32 v21, 98304, v13
    v_lshrrev_b32 v44, 5, v1
    v_mfma_f32_32x32x16_bf16 v[80:95], v[116:119], a[100:103], v[80:95]
    v_xor_b32 v30, 253952, v30
    s_waitcnt vmcnt(23)
    ds_read_b64_tr_b16 v[112:113], v30 offset:0
    ds_read_b64_tr_b16 v[114:115], v30 offset:256
    s_waitcnt lgkmcnt(10)
    v_mfma_f32_32x32x16_bf16 v[80:95], v[120:123], a[104:107], v[80:95]
    ds_read_b64_tr_b16 v[116:117], v30 offset:1024
    ds_read_b64_tr_b16 v[118:119], v30 offset:1280
    v_bfe_u32 v45, v1, 2, 2
    v_lshl_add_u32 v45, v44, 3, v45
    v_and_b32 v46, 3, v1
    v_mfma_f32_32x32x16_bf16 v[80:95], v[124:127], a[108:111], v[80:95]
    ds_read_b64_tr_b16 v[120:121], v30 offset:2048
    ds_read_b64_tr_b16 v[122:123], v30 offset:2304
    v_lshlrev_b32 v46, 3, v46
    v_lshl_add_u32 v45, v45, 7, v46
    s_waitcnt lgkmcnt(10)
    v_mfma_f32_32x32x16_bf16 v[80:95], v[128:131], a[112:115], v[80:95]
    ds_read_b64_tr_b16 v[124:125], v30 offset:3072
    ds_read_b64_tr_b16 v[126:127], v30 offset:3328
    v_and_b32 v46, 16, v1
    v_lshl_add_u32 v45, v46, 1, v45
    v_and_b32 v46, 8, v1
    v_mfma_f32_32x32x16_bf16 v[80:95], v[132:135], a[116:119], v[80:95]
    s_waitcnt vmcnt(18)
    ds_read_b64_tr_b16 v[128:129], v30 offset:4096
    ds_read_b64_tr_b16 v[130:131], v30 offset:4352
    v_lshl_add_u32 v45, v46, 3, v45
    s_waitcnt lgkmcnt(10)
    v_mfma_f32_32x32x16_bf16 v[80:95], v[136:139], a[120:123], v[80:95]
    ds_read_b64_tr_b16 v[132:133], v30 offset:5120
    ds_read_b64_tr_b16 v[134:135], v30 offset:5376
    s_lshl_b32 s20, s74, 6
    s_add_u32 s20, s20, 32768
    v_xor_b32 v23, s20, v45
    v_mfma_f32_32x32x16_bf16 v[80:95], v[140:143], a[124:127], v[80:95]
    ds_read_b64_tr_b16 v[136:137], v30 offset:6144
    ds_read_b64_tr_b16 v[138:139], v30 offset:6400
    v_xor_b32 v22, 64, v23
    v_add_u32 v28, 98304, v22
    v_add_u32 v29, 98304, v23
    s_mul_i32 s20, s74, 0x7ff00000
    v_mfma_f32_32x32x16_bf16 v[80:95], v[188:191], v[184:187], v[80:95]
    v_or_b32 v25, s20, v31
    v_and_b32 v46, 31, v1
    v_lshlrev_b32 v46, 1, v46
    v_lshl_add_u32 v27, v44, 14, v46
    s_waitcnt lgkmcnt(10)
    v_mfma_f32_32x32x16_bf16 v[96:111], v[112:115], a[0:3], 0
    ds_read_b64_tr_b16 v[140:141], v30 offset:7168
    ds_read_b64_tr_b16 v[142:143], v30 offset:7424
    v_lshlrev_b32 v26, 1, v27
    s_lshl_b32 s20, s75, 11
    s_add_u32 s20, s20, s5
    v_mfma_f32_16x16x32_bf16 v[180:183], v[196:199], v[112:115], 0
    s_add_u32 s20, s20, 32768
    v_mul_f32 v80, v0, v80
    v_mul_f32 v81, v0, v81
    v_mfma_f32_32x32x16_bf16 v[96:111], v[116:119], a[4:7], v[96:111]
    v_mul_f32 v82, v0, v82
    v_mul_f32 v83, v0, v83
    v_mul_f32 v84, v0, v84
    v_mul_f32 v85, v0, v85
    v_mul_f32 v86, v0, v86
    v_mul_f32 v87, v0, v87
    v_cvt_pk_bf16_f32 v160, v80, v81
    v_cvt_pk_bf16_f32 v161, v82, v83
    v_cvt_pk_bf16_f32 v162, v84, v85
    v_cvt_pk_bf16_f32 v163, v86, v87
    v_pk_max_i16 v160, v160, 0
    v_mfma_f32_16x16x32_bf16 v[180:183], v[196:199], v[116:119], v[180:183]
    v_pk_max_i16 v161, v161, 0
    v_pk_max_i16 v162, v162, 0
    s_waitcnt lgkmcnt(8)
    v_mfma_f32_32x32x16_bf16 v[96:111], v[120:123], a[8:11], v[96:111]
    v_pk_max_i16 v163, v163, 0
    buffer_store_dwordx4 v[160:163], v31, s[60:63], s20 offen offset:0 sc1
    v_mul_f32 v88, v0, v88
    v_mul_f32 v89, v0, v89
    v_mul_f32 v90, v0, v90
    v_mul_f32 v91, v0, v91
    v_mul_f32 v92, v0, v92
    v_mul_f32 v93, v0, v93
    v_mul_f32 v94, v0, v94
    v_mul_f32 v95, v0, v95
    v_cvt_pk_bf16_f32 v164, v88, v89
    v_mfma_f32_16x16x32_bf16 v[180:183], v[196:199], v[120:123], v[180:183]
    v_cvt_pk_bf16_f32 v165, v90, v91
    v_cvt_pk_bf16_f32 v166, v92, v93
    v_cvt_pk_bf16_f32 v167, v94, v95
    v_mfma_f32_32x32x16_bf16 v[96:111], v[124:127], a[12:15], v[96:111]
    v_pk_max_i16 v164, v164, 0
    v_pk_max_i16 v165, v165, 0
    v_pk_max_i16 v166, v166, 0
    v_pk_max_i16 v167, v167, 0
    buffer_store_dwordx4 v[164:167], v31, s[60:63], s20 offen offset:1024 sc1
    v_mfma_f32_16x16x32_bf16 v[180:183], v[196:199], v[124:127], v[180:183]
    s_waitcnt lgkmcnt(6)
    v_mfma_f32_16x16x32_bf16 v[180:183], v[196:199], v[128:131], v[180:183]
    s_waitcnt lgkmcnt(4)
    v_mfma_f32_16x16x32_bf16 v[180:183], v[196:199], v[132:135], v[180:183]
    s_waitcnt lgkmcnt(2)
    v_mfma_f32_16x16x32_bf16 v[180:183], v[196:199], v[136:139], v[180:183]
    s_waitcnt lgkmcnt(0)
    v_mfma_f32_16x16x32_bf16 v[180:183], v[196:199], v[140:143], v[180:183]
    v_mfma_f32_32x32x16_bf16 v[96:111], v[128:131], a[16:19], v[96:111]
    s_nop 10
    v_cndmask_b32 v180, v180, v181, s[8:9]
    ds_write_b32 v36, v180 offset:1536
    s_waitcnt lgkmcnt(0)
    s_barrier
    v_xor_b32 v30, 8192, v30
    ds_read_b64_tr_b16 v[112:113], v30 offset:0
    ds_read_b64_tr_b16 v[114:115], v30 offset:256
    ds_read_b64_tr_b16 v[116:117], v30 offset:1024
    ds_read_b64_tr_b16 v[118:119], v30 offset:1280
    ds_read_b64_tr_b16 v[120:121], v30 offset:2048
    ds_read_b64_tr_b16 v[122:123], v30 offset:2304
    ds_read_b64_tr_b16 v[124:125], v30 offset:3072
    ds_read_b64_tr_b16 v[126:127], v30 offset:3328
    v_mfma_f32_32x32x16_bf16 v[96:111], v[132:135], a[20:23], v[96:111]
    ds_read_b64_tr_b16 v[128:129], v30 offset:4096
    ds_read_b64_tr_b16 v[130:131], v30 offset:4352
    s_xor_b32 s34, s76, 262144
    s_add_u32 m0, s77, 131072
    s_nop 0
    buffer_load_dwordx4 v14, s[56:59], s34 offen lds
    buffer_load_dwordx4 v15, s[56:59], s34 offen offset:1024 lds
    ds_read_b128 v[44:47], v37 offset:1536
    s_waitcnt lgkmcnt(0)
    v_add_f32 v44, v44, v45
    v_add_f32 v46, v46, v47
    v_add_f32 v44, v44, v46
    v_cvt_pk_bf16_f32 v45, v44, v44
    v_and_b32 v45, 0xffff0000, v45
    v_sub_f32 v44, v44, v45
    v_cvt_pk_bf16_f32 v192, v45, v44
    s_waitcnt vmcnt(4)
    v_cmp_ne_u32 s[20:21], s71, v239
    v_cmp_ne_u32 s[22:23], s71, v241
    v_cmp_ne_u32 s[24:25], s71, v243
    v_cmp_ne_u32 s[26:27], s71, v245
    s_or_b64 s[20:21], s[20:21], s[22:23]
    s_or_b64 s[24:25], s[24:25], s[26:27]
    s_and_b64 s[20:21], s[20:21], s[16:17]
    s_and_b64 s[24:25], s[24:25], s[18:19]
    s_or_b64 vcc, s[20:21], s[24:25]
    s_cbranch_scc0 Ldone6
Lretry6:
    s_cmp_eq_u32 s72, 0
    s_cbranch_scc1 Ldone6
    s_sub_u32 s72, s72, 1
    buffer_load_dwordx4 v[238:241], v6, s[60:63], s28 offen sc1
    buffer_load_dwordx4 v[242:245], v7, s[60:63], s28 offen sc1
    s_waitcnt vmcnt(0)
    v_cmp_ne_u32 s[20:21], s71, v239
    v_cmp_ne_u32 s[22:23], s71, v241
    v_cmp_ne_u32 s[24:25], s71, v243
    v_cmp_ne_u32 s[26:27], s71, v245
    s_or_b64 s[20:21], s[20:21], s[22:23]
    s_or_b64 s[24:25], s[24:25], s[26:27]
    s_and_b64 s[20:21], s[20:21], s[16:17]
    s_and_b64 s[24:25], s[24:25], s[18:19]
    s_or_b64 vcc, s[20:21], s[24:25]
    s_cbranch_scc1 Lretry6
Ldone6:
    v_mov_b32 v239, v240
    v_mov_b32 v243, v244
    v_mul_f32 v234, v230, v238
    v_mul_f32 v235, v230, v239
    v_fma_f32 v234, -v231, v239, v234
    v_fma_f32 v235, v231, v238, v235
    v_fma_f32 v236, v232, v242, v234
    v_fma_f32 v237, v232, v243, v235
    v_fma_f32 v236, -v233, v243, v236
    v_fma_f32 v237, v233, v242, v237
    v_mov_b32 v234, v236
    v_mov_b32 v235, v237
    s_nop 0
    v_permlane32_swap_b32 v234, v236
    v_permlane32_swap_b32 v235, v237
    v_add_f32 v234, v234, v236
    v_add_f32 v235, v235, v237
    ds_write_b64 v39, v[234:235] offset:1024
    s_waitcnt lgkmcnt(0)
    s_barrier
    v_mfma_f32_32x32x16_bf16 v[96:111], v[136:139], a[24:27], v[96:111]
    ds_read_b64_tr_b16 v[132:133], v30 offset:5120
    ds_read_b64_tr_b16 v[134:135], v30 offset:5376
    buffer_load_dwordx4 v16, s[56:59], s34 offen offset:2048 lds
    buffer_load_dwordx4 v17, s[56:59], s34 offen offset:3072 lds
    s_xor_b32 s34, s76, 294912
    s_add_u32 m0, s77, 135168
    s_nop 0
    buffer_load_dwordx4 v14, s[56:59], s34 offen lds
    buffer_load_dwordx4 v15, s[56:59], s34 offen offset:1024 lds
    buffer_load_dwordx4 v16, s[56:59], s34 offen offset:2048 lds
    buffer_load_dwordx4 v17, s[56:59], s34 offen offset:3072 lds
    s_and_b32 s35, s68, 3
    v_mfma_f32_32x32x16_bf16 v[96:111], v[140:143], a[28:31], v[96:111]
    ds_read_b64_tr_b16 v[136:137], v30 offset:6144
    ds_read_b64_tr_b16 v[138:139], v30 offset:6400
    s_lshl_b32 s35, s35, 3
    s_add_u32 s35, s35, s75
    s_lshl_b32 s35, s35, 2
    s_add_u32 s35, s35, s70
    s_lshr_b32 s34, s35, 1
    v_bfe_u32 v168, v1, 2, 3
    v_lshl_add_u32 v168, s34, 3, v168
    v_lshlrev_b32 v168, 10, v168
    v_mfma_f32_32x32x16_bf16 v[96:111], v[112:115], a[32:35], v[96:111]
    ds_read_b64_tr_b16 v[140:141], v30 offset:7168
    ds_read_b64_tr_b16 v[142:143], v30 offset:7424
    v_and_b32 v169, 3, v1
    v_lshl_add_u32 v168, v169, 7, v168
    s_lshl_b32 s34, s74, 9
    buffer_load_dword a255, v168, s[48:51], s34 offen
    ds_read2_b64 v[238:241], v38 offset0:128 offset1:160
    ds_read2_b64 v[242:245], v38 offset0:192 offset1:224
    v_mfma_f32_32x32x16_bf16 v[96:111], v[116:119], a[36:39], v[96:111]
    v_xor_b32 v30, 24576, v30
    ds_read_b64_tr_b16 v[112:113], v30 offset:0
    ds_read_b64_tr_b16 v[114:115], v30 offset:256
    s_waitcnt lgkmcnt(2)
    v_add_f32 v238, v238, v240
    v_add_f32 v242, v242, v244
    v_add_f32 v239, v239, v241
    v_add_f32 v243, v243, v245
    v_add_f32 v254, v238, v242
    v_add_f32 v255, v239, v243
    v_mfma_f32_32x32x16_bf16 v[96:111], v[120:123], a[40:43], v[96:111]
    ds_read_b64_tr_b16 v[116:117], v30 offset:1024
    ds_read_b64_tr_b16 v[118:119], v30 offset:1280
    v_fma_f32 v250, v226, v254, v246
    v_fma_f32 v252, v228, v254, v248
    v_fma_f32 v250, -v228, v255, v250
    v_fma_f32 v252, v226, v255, v252
    v_fma_f32 v251, v227, v254, v247
    v_fma_f32 v253, v229, v254, v249
    v_fma_f32 v251, -v229, v255, v251
    v_fma_f32 v253, v227, v255, v253
    s_waitcnt vmcnt(9)
    v_mfma_f32_32x32x16_bf16 v[96:111], v[124:127], a[44:47], v[96:111]
    ds_read_b64_tr_b16 v[120:121], v30 offset:2048
    ds_read_b64_tr_b16 v[122:123], v30 offset:2304
    buffer_store_dword v43, off, s[60:63], s6 offset:0 sc1
    v_mfma_f32_32x32x16_bf16 v[96:111], v[128:131], a[48:51], v[96:111]
    ds_read_b64_tr_b16 v[124:125], v30 offset:3072
    ds_read_b64_tr_b16 v[126:127], v30 offset:3328
    v_mfma_f32_32x32x16_bf16 v[96:111], v[132:135], a[52:55], v[96:111]
    ds_read_b64_tr_b16 v[128:129], v30 offset:4096
    ds_read_b64_tr_b16 v[130:131], v30 offset:4352
    v_mfma_f32_32x32x16_bf16 v[96:111], v[136:139], a[56:59], v[96:111]
    ds_read_b64_tr_b16 v[132:133], v30 offset:5120
    ds_read_b64_tr_b16 v[134:135], v30 offset:5376
    v_mfma_f32_32x32x16_bf16 v[96:111], v[140:143], a[60:63], v[96:111]
    ds_read_b64_tr_b16 v[136:137], v30 offset:6144
    ds_read_b64_tr_b16 v[138:139], v30 offset:6400
    s_waitcnt lgkmcnt(10)
    v_mfma_f32_32x32x16_bf16 v[96:111], v[112:115], a[64:67], v[96:111]
    ds_read_b64_tr_b16 v[140:141], v30 offset:7168
    ds_read_b64_tr_b16 v[142:143], v30 offset:7424
    v_mfma_f32_32x32x16_bf16 v[96:111], v[116:119], a[68:71], v[96:111]
    v_xor_b32 v30, 8192, v30
    ds_read_b64_tr_b16 v[112:113], v30 offset:0
    ds_read_b64_tr_b16 v[114:115], v30 offset:256
    s_waitcnt lgkmcnt(10)
    v_mfma_f32_32x32x16_bf16 v[96:111], v[120:123], a[72:75], v[96:111]
    ds_read_b64_tr_b16 v[116:117], v30 offset:1024
    ds_read_b64_tr_b16 v[118:119], v30 offset:1280
    v_mfma_f32_32x32x16_bf16 v[96:111], v[124:127], a[76:79], v[96:111]
    ds_read_b64_tr_b16 v[120:121], v30 offset:2048
    ds_read_b64_tr_b16 v[122:123], v30 offset:2304
    s_waitcnt lgkmcnt(10)
    v_mfma_f32_32x32x16_bf16 v[96:111], v[128:131], a[80:83], v[96:111]
    ds_read_b64_tr_b16 v[124:125], v30 offset:3072
    ds_read_b64_tr_b16 v[126:127], v30 offset:3328
    v_mfma_f32_32x32x16_bf16 v[96:111], v[132:135], a[84:87], v[96:111]
    ds_read_b64_tr_b16 v[128:129], v30 offset:4096
    ds_read_b64_tr_b16 v[130:131], v30 offset:4352
    s_waitcnt lgkmcnt(10)
    v_mfma_f32_32x32x16_bf16 v[96:111], v[136:139], a[88:91], v[96:111]
    ds_read_b64_tr_b16 v[132:133], v30 offset:5120
    ds_read_b64_tr_b16 v[134:135], v30 offset:5376
    v_mfma_f32_32x32x16_bf16 v[96:111], v[140:143], a[92:95], v[96:111]
    ds_read_b64_tr_b16 v[136:137], v30 offset:6144
    ds_read_b64_tr_b16 v[138:139], v30 offset:6400
    s_waitcnt lgkmcnt(10)
    v_mfma_f32_32x32x16_bf16 v[96:111], v[112:115], a[96:99], v[96:111]
    ds_read_b64_tr_b16 v[140:141], v30 offset:7168
    ds_read_b64_tr_b16 v[142:143], v30 offset:7424
    v_mfma_f32_32x32x16_bf16 v[96:111], v[116:119], a[100:103], v[96:111]
    v_xor_b32 v30, 122880, v30
    ds_read_b64_tr_b16 v[112:113], v30 offset:0
    ds_read_b64_tr_b16 v[114:115], v30 offset:256
    s_waitcnt lgkmcnt(10)
    v_mfma_f32_32x32x16_bf16 v[96:111], v[120:123], a[104:107], v[96:111]
    ds_read_b64_tr_b16 v[116:117], v30 offset:1024
    ds_read_b64_tr_b16 v[118:119], v30 offset:1280
    v_mfma_f32_32x32x16_bf16 v[96:111], v[124:127], a[108:111], v[96:111]
    ds_read_b64_tr_b16 v[120:121], v30 offset:2048
    ds_read_b64_tr_b16 v[122:123], v30 offset:2304
    s_waitcnt lgkmcnt(10)
    v_mfma_f32_32x32x16_bf16 v[96:111], v[128:131], a[112:115], v[96:111]
    ds_read_b64_tr_b16 v[124:125], v30 offset:3072
    ds_read_b64_tr_b16 v[126:127], v30 offset:3328
    v_mfma_f32_32x32x16_bf16 v[96:111], v[132:135], a[116:119], v[96:111]
    ds_read_b64_tr_b16 v[128:129], v30 offset:4096
    ds_read_b64_tr_b16 v[130:131], v30 offset:4352
    s_waitcnt lgkmcnt(10)
    v_mfma_f32_32x32x16_bf16 v[96:111], v[136:139], a[120:123], v[96:111]
    ds_read_b64_tr_b16 v[132:133], v30 offset:5120
    ds_read_b64_tr_b16 v[134:135], v30 offset:5376
    v_mfma_f32_32x32x16_bf16 v[96:111], v[140:143], a[124:127], v[96:111]
    ds_read_b64_tr_b16 v[136:137], v30 offset:6144
    ds_read_b64_tr_b16 v[138:139], v30 offset:6400
    v_mfma_f32_32x32x16_bf16 v[96:111], v[192:195], v[184:187], v[96:111]
    s_waitcnt lgkmcnt(10)
    v_mfma_f32_32x32x16_bf16 v[80:95], v[112:115], a[0:3], 0
    ds_read_b64_tr_b16 v[140:141], v30 offset:7168
    ds_read_b64_tr_b16 v[142:143], v30 offset:7424
    v_mfma_f32_16x16x32_bf16 v[176:179], v[196:199], v[112:115], 0
    v_mfma_f32_32x32x16_bf16 v[80:95], v[116:119], a[4:7], v[80:95]
    v_mfma_f32_16x16x32_bf16 v[176:179], v[196:199], v[116:119], v[176:179]
    s_waitcnt lgkmcnt(8)
    v_mfma_f32_32x32x16_bf16 v[80:95], v[120:123], a[8:11], v[80:95]
    v_mfma_f32_16x16x32_bf16 v[176:179], v[196:199], v[120:123], v[176:179]
    v_mfma_f32_32x32x16_bf16 v[80:95], v[124:127], a[12:15], v[80:95]
    v_mfma_f32_16x16x32_bf16 v[176:179], v[196:199], v[124:127], v[176:179]
    s_waitcnt lgkmcnt(6)
    v_mfma_f32_16x16x32_bf16 v[176:179], v[196:199], v[128:131], v[176:179]
    s_waitcnt lgkmcnt(4)
    v_mfma_f32_16x16x32_bf16 v[176:179], v[196:199], v[132:135], v[176:179]
    s_waitcnt lgkmcnt(2)
    v_mfma_f32_16x16x32_bf16 v[176:179], v[196:199], v[136:139], v[176:179]
    s_waitcnt lgkmcnt(0)
    v_mfma_f32_16x16x32_bf16 v[176:179], v[196:199], v[140:143], v[176:179]
    v_mfma_f32_32x32x16_bf16 v[80:95], v[128:131], a[16:19], v[80:95]
    s_nop 10
    v_cndmask_b32 v176, v176, v177, s[8:9]
    ds_write_b32 v36, v176 offset:2048
    s_waitcnt lgkmcnt(0)
    s_barrier
    v_xor_b32 v30, 8192, v30
    ds_read_b64_tr_b16 v[112:113], v30 offset:0
    ds_read_b64_tr_b16 v[114:115], v30 offset:256
    ds_read_b64_tr_b16 v[116:117], v30 offset:1024
    ds_read_b64_tr_b16 v[118:119], v30 offset:1280
    ds_read_b64_tr_b16 v[120:121], v30 offset:2048
    ds_read_b64_tr_b16 v[122:123], v30 offset:2304
    ds_read_b64_tr_b16 v[124:125], v30 offset:3072
    ds_read_b64_tr_b16 v[126:127], v30 offset:3328
    v_mfma_f32_32x32x16_bf16 v[80:95], v[132:135], a[20:23], v[80:95]
    ds_read_b64_tr_b16 v[128:129], v30 offset:4096
    ds_read_b64_tr_b16 v[130:131], v30 offset:4352
    s_xor_b32 s34, s4, 32768
    s_add_u32 m0, s77, 98304
    s_nop 0
    buffer_load_dwordx4 v2, s[48:51], s34 offen lds
    buffer_load_dwordx4 v3, s[48:51], s34 offen offset:1024 lds
    buffer_load_dwordx4 v4, s[48:51], s34 offen offset:2048 lds
    buffer_load_dwordx4 v5, s[48:51], s34 offen offset:3072 lds
    v_mfma_f32_32x32x16_bf16 v[80:95], v[136:139], a[24:27], v[80:95]
    ds_read_b64_tr_b16 v[132:133], v30 offset:5120
    ds_read_b64_tr_b16 v[134:135], v30 offset:5376
    s_add_u32 m0, s77, 102400
    s_nop 0
    buffer_load_dwordx4 v2, s[48:51], s4 offen lds
    buffer_load_dwordx4 v3, s[48:51], s4 offen offset:1024 lds
    buffer_load_dwordx4 v4, s[48:51], s4 offen offset:2048 lds
    buffer_load_dwordx4 v5, s[48:51], s4 offen offset:3072 lds
    v_mfma_f32_32x32x16_bf16 v[80:95], v[140:143], a[28:31], v[80:95]
    ds_read_b64_tr_b16 v[136:137], v30 offset:6144
    ds_read_b64_tr_b16 v[138:139], v30 offset:6400
    s_waitcnt lgkmcnt(10)
    v_mfma_f32_32x32x16_bf16 v[80:95], v[112:115], a[32:35], v[80:95]
    ds_read_b64_tr_b16 v[140:141], v30 offset:7168
    ds_read_b64_tr_b16 v[142:143], v30 offset:7424
    v_mfma_f32_32x32x16_bf16 v[80:95], v[116:119], a[36:39], v[80:95]
    v_xor_b32 v30, 24576, v30
    ds_read_b64_tr_b16 v[112:113], v30 offset:0
    ds_read_b64_tr_b16 v[114:115], v30 offset:256
    s_waitcnt lgkmcnt(10)
    v_mfma_f32_32x32x16_bf16 v[80:95], v[120:123], a[40:43], v[80:95]
    ds_read_b64_tr_b16 v[116:117], v30 offset:1024
    ds_read_b64_tr_b16 v[118:119], v30 offset:1280
    v_mfma_f32_32x32x16_bf16 v[80:95], v[124:127], a[44:47], v[80:95]
    ds_read_b64_tr_b16 v[120:121], v30 offset:2048
    ds_read_b64_tr_b16 v[122:123], v30 offset:2304
    s_waitcnt lgkmcnt(10)
    v_mfma_f32_32x32x16_bf16 v[80:95], v[128:131], a[48:51], v[80:95]
    ds_read_b64_tr_b16 v[124:125], v30 offset:3072
    ds_read_b64_tr_b16 v[126:127], v30 offset:3328
    buffer_load_dword v24, v40, s[60:63], 0 offen sc1
    v_mfma_f32_32x32x16_bf16 v[80:95], v[132:135], a[52:55], v[80:95]
    ds_read_b64_tr_b16 v[128:129], v30 offset:4096
    ds_read_b64_tr_b16 v[130:131], v30 offset:4352
    s_waitcnt lgkmcnt(10)
    v_mfma_f32_32x32x16_bf16 v[80:95], v[136:139], a[56:59], v[80:95]
    ds_read_b64_tr_b16 v[132:133], v30 offset:5120
    ds_read_b64_tr_b16 v[134:135], v30 offset:5376
    v_mfma_f32_32x32x16_bf16 v[80:95], v[140:143], a[60:63], v[80:95]
    ds_read_b64_tr_b16 v[136:137], v30 offset:6144
    ds_read_b64_tr_b16 v[138:139], v30 offset:6400
    s_waitcnt lgkmcnt(10)
    v_mfma_f32_32x32x16_bf16 v[80:95], v[112:115], a[64:67], v[80:95]
    ds_read_b64_tr_b16 v[140:141], v30 offset:7168
    ds_read_b64_tr_b16 v[142:143], v30 offset:7424
    v_mfma_f32_32x32x16_bf16 v[80:95], v[116:119], a[68:71], v[80:95]
    v_xor_b32 v30, 8192, v30
    ds_read_b64_tr_b16 v[112:113], v30 offset:0
    ds_read_b64_tr_b16 v[114:115], v30 offset:256
    s_waitcnt lgkmcnt(10)
    v_mfma_f32_32x32x16_bf16 v[80:95], v[120:123], a[72:75], v[80:95]
    ds_read_b64_tr_b16 v[116:117], v30 offset:1024
    ds_read_b64_tr_b16 v[118:119], v30 offset:1280
    v_pk_fma_f32 v[144:145], v[210:211], v[250:251], v[144:145] op_sel_hi:[0,1,1]
    v_pk_fma_f32 v[64:65], v[210:211], v[252:253], v[64:65] op_sel_hi:[0,1,1] neg_lo:[1,0,0] neg_hi:[1,0,0]
    v_pk_fma_f32 v[144:145], v[210:211], v[252:253], v[144:145] op_sel:[1,0,0] op_sel_hi:[1,1,1] neg_lo:[1,0,0] neg_hi:[1,0,0]
    v_pk_fma_f32 v[64:65], v[210:211], v[250:251], v[64:65] op_sel:[1,0,0] op_sel_hi:[1,1,1] neg_lo:[1,0,0] neg_hi:[1,0,0]
    v_pk_fma_f32 v[146:147], v[212:213], v[250:251], v[146:147] op_sel_hi:[0,1,1]
    v_pk_fma_f32 v[66:67], v[212:213], v[252:253], v[66:67] op_sel_hi:[0,1,1] neg_lo:[1,0,0] neg_hi:[1,0,0]
    v_pk_fma_f32 v[146:147], v[212:213], v[252:253], v[146:147] op_sel:[1,0,0] op_sel_hi:[1,1,1] neg_lo:[1,0,0] neg_hi:[1,0,0]
    v_pk_fma_f32 v[66:67], v[212:213], v[250:251], v[66:67] op_sel:[1,0,0] op_sel_hi:[1,1,1] neg_lo:[1,0,0] neg_hi:[1,0,0]
    v_pk_fma_f32 v[148:149], v[214:215], v[250:251], v[148:149] op_sel_hi:[0,1,1]
    v_pk_fma_f32 v[68:69], v[214:215], v[252:253], v[68:69] op_sel_hi:[0,1,1] neg_lo:[1,0,0] neg_hi:[1,0,0]
    v_pk_fma_f32 v[148:149], v[214:215], v[252:253], v[148:149] op_sel:[1,0,0] op_sel_hi:[1,1,1] neg_lo:[1,0,0] neg_hi:[1,0,0]
    v_pk_fma_f32 v[68:69], v[214:215], v[250:251], v[68:69] op_sel:[1,0,0] op_sel_hi:[1,1,1] neg_lo:[1,0,0] neg_hi:[1,0,0]
    v_pk_fma_f32 v[150:151], v[216:217], v[250:251], v[150:151] op_sel_hi:[0,1,1]
    v_pk_fma_f32 v[70:71], v[216:217], v[252:253], v[70:71] op_sel_hi:[0,1,1] neg_lo:[1,0,0] neg_hi:[1,0,0]
    v_pk_fma_f32 v[150:151], v[216:217], v[252:253], v[150:151] op_sel:[1,0,0] op_sel_hi:[1,1,1] neg_lo:[1,0,0] neg_hi:[1,0,0]
    v_pk_fma_f32 v[70:71], v[216:217], v[250:251], v[70:71] op_sel:[1,0,0] op_sel_hi:[1,1,1] neg_lo:[1,0,0] neg_hi:[1,0,0]
    v_pk_fma_f32 v[152:153], v[218:219], v[250:251], v[152:153] op_sel_hi:[0,1,1]
    v_pk_fma_f32 v[72:73], v[218:219], v[252:253], v[72:73] op_sel_hi:[0,1,1] neg_lo:[1,0,0] neg_hi:[1,0,0]
    v_pk_fma_f32 v[152:153], v[218:219], v[252:253], v[152:153] op_sel:[1,0,0] op_sel_hi:[1,1,1] neg_lo:[1,0,0] neg_hi:[1,0,0]
    v_pk_fma_f32 v[72:73], v[218:219], v[250:251], v[72:73] op_sel:[1,0,0] op_sel_hi:[1,1,1] neg_lo:[1,0,0] neg_hi:[1,0,0]
    v_pk_fma_f32 v[154:155], v[220:221], v[250:251], v[154:155] op_sel_hi:[0,1,1]
    v_pk_fma_f32 v[74:75], v[220:221], v[252:253], v[74:75] op_sel_hi:[0,1,1] neg_lo:[1,0,0] neg_hi:[1,0,0]
    v_pk_fma_f32 v[154:155], v[220:221], v[252:253], v[154:155] op_sel:[1,0,0] op_sel_hi:[1,1,1] neg_lo:[1,0,0] neg_hi:[1,0,0]
    v_pk_fma_f32 v[74:75], v[220:221], v[250:251], v[74:75] op_sel:[1,0,0] op_sel_hi:[1,1,1] neg_lo:[1,0,0] neg_hi:[1,0,0]
    v_pk_fma_f32 v[156:157], v[222:223], v[250:251], v[156:157] op_sel_hi:[0,1,1]
    v_pk_fma_f32 v[76:77], v[222:223], v[252:253], v[76:77] op_sel_hi:[0,1,1] neg_lo:[1,0,0] neg_hi:[1,0,0]
    v_pk_fma_f32 v[156:157], v[222:223], v[252:253], v[156:157] op_sel:[1,0,0] op_sel_hi:[1,1,1] neg_lo:[1,0,0] neg_hi:[1,0,0]
    v_pk_fma_f32 v[76:77], v[222:223], v[250:251], v[76:77] op_sel:[1,0,0] op_sel_hi:[1,1,1] neg_lo:[1,0,0] neg_hi:[1,0,0]
    v_pk_fma_f32 v[158:159], v[224:225], v[250:251], v[158:159] op_sel_hi:[0,1,1]
    v_pk_fma_f32 v[78:79], v[224:225], v[252:253], v[78:79] op_sel_hi:[0,1,1] neg_lo:[1,0,0] neg_hi:[1,0,0]
    v_pk_fma_f32 v[158:159], v[224:225], v[252:253], v[158:159] op_sel:[1,0,0] op_sel_hi:[1,1,1] neg_lo:[1,0,0] neg_hi:[1,0,0]
    v_pk_fma_f32 v[78:79], v[224:225], v[250:251], v[78:79] op_sel:[1,0,0] op_sel_hi:[1,1,1] neg_lo:[1,0,0] neg_hi:[1,0,0]
    v_mfma_f32_32x32x16_bf16 v[80:95], v[124:127], a[76:79], v[80:95]
    ds_read_b64_tr_b16 v[120:121], v30 offset:2048
    ds_read_b64_tr_b16 v[122:123], v30 offset:2304
    v_cvt_pk_bf16_f32 v48, v144, v145
    v_cvt_pk_bf16_f32 v49, v146, v147
    v_cvt_pk_bf16_f32 v50, v148, v149
    v_cvt_pk_bf16_f32 v51, v150, v151
    s_waitcnt lgkmcnt(10)
    v_mfma_f32_32x32x16_bf16 v[80:95], v[128:131], a[80:83], v[80:95]
    ds_read_b64_tr_b16 v[124:125], v30 offset:3072
    ds_read_b64_tr_b16 v[126:127], v30 offset:3328
    v_cvt_pk_bf16_f32 v52, v152, v153
    v_cvt_pk_bf16_f32 v53, v154, v155
    v_cvt_pk_bf16_f32 v54, v156, v157
    v_cvt_pk_bf16_f32 v55, v158, v159
    v_cvt_pk_bf16_f32 v56, v64, v65
    v_cvt_pk_bf16_f32 v57, v66, v67
    v_cvt_pk_bf16_f32 v58, v68, v69
    v_cvt_pk_bf16_f32 v59, v70, v71
    v_cvt_pk_bf16_f32 v60, v72, v73
    v_mfma_f32_32x32x16_bf16 v[80:95], v[132:135], a[84:87], v[80:95]
    ds_read_b64_tr_b16 v[128:129], v30 offset:4096
    ds_read_b64_tr_b16 v[130:131], v30 offset:4352
    v_cvt_pk_bf16_f32 v61, v74, v75
    v_cvt_pk_bf16_f32 v62, v76, v77
    v_cvt_pk_bf16_f32 v63, v78, v79
    ds_write_b64 v32, v[48:49] offset:0
    ds_write_b64 v32, v[56:57] offset:2048
    v_xor_b32 v33, 16, v32
    ds_write_b64 v33, v[50:51] offset:0
    ds_write_b64 v33, v[58:59] offset:2048
    s_waitcnt lgkmcnt(14)
    v_mfma_f32_32x32x16_bf16 v[80:95], v[136:139], a[88:91], v[80:95]
    ds_read_b64_tr_b16 v[132:133], v30 offset:5120
    ds_read_b64_tr_b16 v[134:135], v30 offset:5376
    v_xor_b32 v33, 32, v32
    ds_write_b64 v33, v[52:53] offset:0
    ds_write_b64 v33, v[60:61] offset:2048
    v_xor_b32 v33, 48, v32
    ds_write_b64 v33, v[54:55] offset:0
    ds_write_b64 v33, v[62:63] offset:2048
    s_lshl_b32 s20, s75, 12
    s_add_u32 s20, s20, s5
    s_waitcnt lgkmcnt(0)
    v_mfma_f32_32x32x16_bf16 v[80:95], v[140:143], a[92:95], v[80:95]
    ds_read_b64_tr_b16 v[136:137], v30 offset:6144
    ds_read_b64_tr_b16 v[138:139], v30 offset:6400
    ds_read_b64_tr_b16 v[144:145], v34 offset:0
    ds_read_b64_tr_b16 v[146:147], v35 offset:0
    ds_read_b64_tr_b16 v[148:149], v34 offset:1024
    ds_read_b64_tr_b16 v[150:151], v35 offset:1024
    ds_read_b64_tr_b16 v[152:153], v34 offset:2048
    ds_read_b64_tr_b16 v[154:155], v35 offset:2048
    ds_read_b64_tr_b16 v[156:157], v34 offset:3072
    ds_read_b64_tr_b16 v[158:159], v35 offset:3072
    v_mfma_f32_32x32x16_bf16 v[80:95], v[112:115], a[96:99], v[80:95]
    ds_read_b64_tr_b16 v[140:141], v30 offset:7168
    ds_read_b64_tr_b16 v[142:143], v30 offset:7424
    v_mfma_f32_32x32x16_bf16 v[80:95], v[116:119], a[100:103], v[80:95]
    ds_read_b64_tr_b16 v[112:113], v22 offset:0
    ds_read_b64_tr_b16 v[114:115], v22 offset:512
    s_waitcnt lgkmcnt(10)
    buffer_store_dwordx4 v[144:147], v31, s[60:63], s20 offen offset:0 sc1
    s_waitcnt lgkmcnt(8)
    buffer_store_dwordx4 v[148:151], v31, s[60:63], s20 offen offset:1024 sc1
    s_waitcnt lgkmcnt(6)
    buffer_store_dwordx4 v[152:155], v31, s[60:63], s20 offen offset:2048 sc1
    s_waitcnt lgkmcnt(4)
    buffer_store_dwordx4 v[156:159], v31, s[60:63], s20 offen offset:3072 sc1
    v_mfma_f32_32x32x16_bf16 v[80:95], v[120:123], a[104:107], v[80:95]
    ds_read_b64_tr_b16 v[116:117], v23 offset:0
    ds_read_b64_tr_b16 v[118:119], v23 offset:512
    s_lshl_b32 s20, s75, 11
    s_add_u32 s20, s20, s5
    s_add_u32 s20, s20, 49152
    v_mul_f32 v96, v0, v96
    v_mul_f32 v97, v0, v97
    v_mul_f32 v98, v0, v98
    v_mul_f32 v99, v0, v99
    v_mul_f32 v100, v0, v100
    v_mul_f32 v101, v0, v101
    v_mfma_f32_32x32x16_bf16 v[80:95], v[124:127], a[108:111], v[80:95]
    ds_read_b64_tr_b16 v[120:121], v22 offset:2048
    ds_read_b64_tr_b16 v[122:123], v22 offset:2560
    v_mul_f32 v102, v0, v102
    v_mul_f32 v103, v0, v103
    v_cvt_pk_bf16_f32 v168, v96, v97
    v_cvt_pk_bf16_f32 v169, v98, v99
    v_cvt_pk_bf16_f32 v170, v100, v101
    v_cvt_pk_bf16_f32 v171, v102, v103
    v_pk_max_i16 v168, v168, 0
    v_pk_max_i16 v169, v169, 0
    v_mfma_f32_32x32x16_bf16 v[80:95], v[128:131], a[112:115], v[80:95]
    ds_read_b64_tr_b16 v[124:125], v23 offset:2048
    ds_read_b64_tr_b16 v[126:127], v23 offset:2560
    v_pk_max_i16 v170, v170, 0
    v_pk_max_i16 v171, v171, 0
    buffer_store_dwordx4 v[168:171], v31, s[60:63], s20 offen offset:0 sc1
    v_mul_f32 v104, v0, v104
    v_mul_f32 v105, v0, v105
    v_mul_f32 v106, v0, v106
    v_mul_f32 v107, v0, v107
    v_mul_f32 v108, v0, v108
    v_mul_f32 v109, v0, v109
    v_mfma_f32_32x32x16_bf16 v[80:95], v[132:135], a[116:119], v[80:95]
    v_mul_f32 v110, v0, v110
    v_mul_f32 v111, v0, v111
    v_cvt_pk_bf16_f32 v172, v104, v105
    v_cvt_pk_bf16_f32 v173, v106, v107
    v_cvt_pk_bf16_f32 v174, v108, v109
    v_cvt_pk_bf16_f32 v175, v110, v111
    v_pk_max_i16 v172, v172, 0
    v_pk_max_i16 v173, v173, 0
    v_pk_max_i16 v174, v174, 0
    v_pk_max_i16 v175, v175, 0
    buffer_store_dwordx4 v[172:175], v31, s[60:63], s20 offen offset:1024 sc1
    ds_read_b128 v[44:47], v37 offset:2048
    s_waitcnt lgkmcnt(0)
    v_add_f32 v44, v44, v45
    v_add_f32 v46, v46, v47
    v_add_f32 v44, v44, v46
    v_cvt_pk_bf16_f32 v45, v44, v44
    v_and_b32 v45, 0xffff0000, v45
    v_sub_f32 v44, v44, v45
    v_cvt_pk_bf16_f32 v188, v45, v44
    s_waitcnt vmcnt(7)
    s_barrier
    v_mfma_f32_32x32x16_bf16 v[80:95], v[136:139], a[120:123], v[80:95]
    ds_read_b64_tr_b16 v[128:129], v28 offset:0
    ds_read_b64_tr_b16 v[130:131], v28 offset:512
    ds_read_b64_tr_b16 v[132:133], v29 offset:0
    ds_read_b64_tr_b16 v[134:135], v29 offset:512
    s_xor_b32 s34, s4, 33024
    s_add_u32 m0, s77, 0
    s_nop 0
    buffer_load_dwordx4 v2, s[48:51], s34 offen lds
    buffer_load_dwordx4 v3, s[48:51], s34 offen offset:1024 lds
    s_waitcnt vmcnt(4)
    buffer_store_dword v43, off, s[60:63], s6 offset:96 sc1
    s_waitcnt vmcnt(3)
    v_mfma_f32_32x32x16_bf16 v[80:95], v[140:143], a[124:127], v[80:95]
    ds_read_b64_tr_b16 v[136:137], v28 offset:2048
    ds_read_b64_tr_b16 v[138:139], v28 offset:2560
    buffer_load_dwordx4 v4, s[48:51], s34 offen offset:2048 lds
    buffer_store_dword v43, off, s[60:63], s6 offset:32 sc1
    v_mfma_f32_32x32x16_bf16 v[80:95], v[188:191], v[184:187], v[80:95]
    buffer_load_dwordx4 v5, s[48:51], s34 offen offset:3072 lds
    s_xor_b32 s34, s4, 256
    s_add_u32 m0, s77, 4096
    v_mfma_f32_32x32x16_bf16 v[48:63], v[160:163], v[112:115], 0
    ds_read_b64_tr_b16 v[140:141], v29 offset:2048
    ds_read_b64_tr_b16 v[142:143], v29 offset:2560
    buffer_load_dwordx4 v2, s[48:51], s34 offen lds
    s_lshl_b32 s20, s75, 11
    s_add_u32 s20, s20, s5
    s_add_u32 s20, s20, 65536
    s_nop 1
    v_mul_f32 v80, v0, v80
    v_mul_f32 v81, v0, v81
    v_mul_f32 v82, v0, v82
    v_mul_f32 v83, v0, v83
    v_mul_f32 v84, v0, v84
    v_mfma_f32_32x32x16_bf16 v[64:79], v[160:163], v[116:119], 0
    ds_read_b128 v[112:115], v18 offset:0
    buffer_load_dwordx4 v3, s[48:51], s34 offen offset:1024 lds
    v_mul_f32 v85, v0, v85
    v_mul_f32 v86, v0, v86
    v_mul_f32 v87, v0, v87
    v_cvt_pk_bf16_f32 v176, v80, v81
    v_cvt_pk_bf16_f32 v177, v82, v83
    v_cvt_pk_bf16_f32 v178, v84, v85
    v_cvt_pk_bf16_f32 v179, v86, v87
    v_pk_max_i16 v176, v176, 0
    v_mfma_f32_32x32x16_bf16 v[48:63], v[164:167], v[120:123], v[48:63]
    ds_read_b128 v[116:119], v18 offset:4096
    buffer_load_dwordx4 v4, s[48:51], s34 offen offset:2048 lds
    v_pk_max_i16 v177, v177, 0
    v_pk_max_i16 v178, v178, 0
    v_pk_max_i16 v179, v179, 0
    buffer_store_dwordx4 v[176:179], v31, s[60:63], s20 offen offset:0 sc1
    v_mul_f32 v88, v0, v88
    v_mul_f32 v89, v0, v89
    v_mul_f32 v90, v0, v90
    v_mul_f32 v91, v0, v91
    v_mul_f32 v92, v0, v92
    v_mfma_f32_32x32x16_bf16 v[64:79], v[164:167], v[124:127], v[64:79]
    ds_read_b128 v[120:123], v19 offset:0
    buffer_load_dwordx4 v5, s[48:51], s34 offen offset:3072 lds
    v_cmp_ne_u32 vcc, s71, v24
    s_and_b32 s31, vcc_lo, 0xff
    s_cbranch_scc0 Ldone2
Lretry2:
    s_cmp_eq_u32 s72, 0
    s_cbranch_scc1 Ldone2
    s_sub_u32 s72, s72, 1
    buffer_load_dword v24, v40, s[60:63], 0 offen sc1
    s_waitcnt vmcnt(0)
    v_cmp_ne_u32 vcc, s71, v24
    s_and_b32 s31, vcc_lo, 0xff
    s_cbranch_scc1 Lretry2
Ldone2:
    s_lshl_b32 s30, s75, 11
    s_add_u32 s30, s30, s5
    s_add_u32 s30, s30, 32768
    s_xor_b32 s29, s30, 2048
    s_waitcnt lgkmcnt(7)
    v_mfma_f32_32x32x16_bf16 v[48:63], v[168:171], v[128:131], v[48:63]
    ds_read_b128 v[124:127], v19 offset:4096
    buffer_load_dwordx4 a[128:131], v31, s[60:63], s29 offen offset:0 sc1
    v_mul_f32 v93, v0, v93
    v_mul_f32 v94, v0, v94
    v_mul_f32 v95, v0, v95
    v_cvt_pk_bf16_f32 v180, v88, v89
    v_cvt_pk_bf16_f32 v181, v90, v91
    v_cvt_pk_bf16_f32 v182, v92, v93
    v_cvt_pk_bf16_f32 v183, v94, v95
    v_pk_max_i16 v180, v180, 0
    v_pk_max_i16 v181, v181, 0
    v_mfma_f32_32x32x16_bf16 v[64:79], v[168:171], v[132:135], v[64:79]
    ds_read_b128 v[128:131], v18 offset:8192
    buffer_load_dwordx4 a[132:135], v31, s[60:63], s29 offen offset:1024 sc1
    s_xor_b32 s29, s30, 4096
    v_pk_max_i16 v182, v182, 0
    v_pk_max_i16 v183, v183, 0
    buffer_store_dwordx4 v[180:183], v31, s[60:63], s20 offen offset:1024 sc1
    s_waitcnt vmcnt(0)
    buffer_store_dword v43, off, s[60:63], s6 offset:64 sc1
    s_mov_b32 s23, 0x30003
    v_mul_u32_u24 v7, 5, v1
    s_waitcnt lgkmcnt(5)
    v_mfma_f32_32x32x16_bf16 v[48:63], v[172:175], v[136:139], v[48:63]
    ds_read_b128 v[132:135], v18 offset:12288
    buffer_load_dwordx4 a[136:139], v31, s[60:63], s29 offen offset:0 sc1
    v_alignbit_b32 v6, v43, v43, v7
    v_lshrrev_b32 v7, 2, v6
    v_lshrrev_b32 v8, 4, v6
    s_lshl_b32 s24, s73, 3
    v_mfma_f32_32x32x16_bf16 v[64:79], v[172:175], v[140:143], v[64:79]
    ds_read_b128 v[136:139], v19 offset:8192
    buffer_load_dwordx4 a[140:143], v31, s[60:63], s29 offen offset:1024 sc1
    s_xor_b32 s29, s30, 6144
    s_add_u32 s24, s24, s75
    s_lshl_b32 s24, s24, 1
    s_waitcnt lgkmcnt(5)
    v_mfma_f32_32x32x16_bf16 v[48:63], v[144:147], v[112:115], v[48:63]
    ds_read_b128 v[140:143], v19 offset:12288
    buffer_load_dwordx4 a[144:147], v31, s[60:63], s29 offen offset:0 sc1
    s_add_u32 s24, s24, s74
    s_lshl_b32 s24, s24, 11
    s_add_u32 s24, s24, 327680
    v_mfma_f32_32x32x16_bf16 v[64:79], v[144:147], v[116:119], v[64:79]
    ds_read_b64_tr_b16 v[112:113], v22 offset:4096
    ds_read_b64_tr_b16 v[114:115], v22 offset:4608
    buffer_load_dwordx4 a[148:151], v31, s[60:63], s29 offen offset:1024 sc1
    s_xor_b32 s29, s30, 8192
    s_waitcnt lgkmcnt(6)
    v_mfma_f32_32x32x16_bf16 v[48:63], v[148:151], v[120:123], v[48:63]
    ds_read_b64_tr_b16 v[116:117], v23 offset:4096
    ds_read_b64_tr_b16 v[118:119], v23 offset:4608
    buffer_load_dwordx4 a[152:155], v31, s[60:63], s29 offen offset:0 sc1
    v_mfma_f32_32x32x16_bf16 v[64:79], v[148:151], v[124:127], v[64:79]
    ds_read_b64_tr_b16 v[120:121], v22 offset:6144
    ds_read_b64_tr_b16 v[122:123], v22 offset:6656
    buffer_load_dwordx4 a[156:159], v31, s[60:63], s29 offen offset:1024 sc1
    s_xor_b32 s29, s30, 10240
    s_waitcnt lgkmcnt(8)
    v_mfma_f32_32x32x16_bf16 v[48:63], v[152:155], v[128:131], v[48:63]
    ds_read_b64_tr_b16 v[124:125], v23 offset:6144
    ds_read_b64_tr_b16 v[126:127], v23 offset:6656
    buffer_load_dwordx4 a[160:163], v31, s[60:63], s29 offen offset:0 sc1
    v_mfma_f32_32x32x16_bf16 v[64:79], v[152:155], v[132:135], v[64:79]
    ds_read_b64_tr_b16 v[128:129], v22 offset:8192
    ds_read_b64_tr_b16 v[130:131], v22 offset:8704
    buffer_load_dwordx4 a[164:167], v31, s[60:63], s29 offen offset:1024 sc1
    s_xor_b32 s29, s30, 12288
    s_waitcnt lgkmcnt(10)
    v_mfma_f32_32x32x16_bf16 v[48:63], v[156:159], v[136:139], v[48:63]
    ds_read_b64_tr_b16 v[132:133], v23 offset:8192
    ds_read_b64_tr_b16 v[134:135], v23 offset:8704
    buffer_load_dwordx4 a[168:171], v31, s[60:63], s29 offen offset:0 sc1
    v_mfma_f32_32x32x16_bf16 v[64:79], v[156:159], v[140:143], v[64:79]
    ds_read_b64_tr_b16 v[136:137], v22 offset:10240
    ds_read_b64_tr_b16 v[138:139], v22 offset:10752
    buffer_load_dwordx4 a[172:175], v31, s[60:63], s29 offen offset:1024 sc1
    s_xor_b32 s29, s30, 14336
    s_waitcnt lgkmcnt(10)
    v_mfma_f32_32x32x16_bf16 v[48:63], a[128:131], v[112:115], v[48:63]
    ds_read_b64_tr_b16 v[140:141], v23 offset:10240
    ds_read_b64_tr_b16 v[142:143], v23 offset:10752
    buffer_load_dwordx4 a[176:179], v31, s[60:63], s29 offen offset:0 sc1
    v_mfma_f32_32x32x16_bf16 v[64:79], a[128:131], v[116:119], v[64:79]
    ds_read_b64_tr_b16 v[112:113], v22 offset:12288
    ds_read_b64_tr_b16 v[114:115], v22 offset:12800
    buffer_load_dwordx4 a[180:183], v31, s[60:63], s29 offen offset:1024 sc1
    s_and_b32 s31, s6, -32
    s_buffer_load_dwordx8 s[40:47], s[60:63], s31 offset:96 glc
    s_waitcnt lgkmcnt(10)
    v_mfma_f32_32x32x16_bf16 v[48:63], a[132:135], v[120:123], v[48:63]
    ds_read_b64_tr_b16 v[116:117], v23 offset:12288
    ds_read_b64_tr_b16 v[118:119], v23 offset:12800
    s_mul_i32 s34, s70, 49152
    s_add_u32 s34, s34, 524288
    v_mfma_f32_32x32x16_bf16 v[64:79], a[132:135], v[124:127], v[64:79]
    ds_read_b64_tr_b16 v[120:121], v22 offset:14336
    ds_read_b64_tr_b16 v[122:123], v22 offset:14848
    s_mul_i32 s35, s70, 6144
    s_add_u32 m0, s35, 65536
    s_waitcnt lgkmcnt(10)
    s_waitcnt vmcnt(11)
    v_mfma_f32_32x32x16_bf16 v[48:63], a[136:139], v[128:131], v[48:63]
    ds_read_b64_tr_b16 v[124:125], v23 offset:14336
    ds_read_b64_tr_b16 v[126:127], v23 offset:14848
    buffer_load_dwordx4 v14, s[56:59], s34 offen lds
    buffer_load_dwordx4 v15, s[56:59], s34 offen offset:1024 lds
    s_add_u32 s34, s34, 16384
    v_mfma_f32_32x32x16_bf16 v[64:79], a[136:139], v[132:135], v[64:79]
    ds_read_b64_tr_b16 v[128:129], v22 offset:16384
    ds_read_b64_tr_b16 v[130:131], v22 offset:16896
    s_lshl_b32 s3, s74, 15
    s_sub_u32 s3, 688128, s3
    s_waitcnt lgkmcnt(10)
    s_waitcnt vmcnt(12)
    v_mfma_f32_32x32x16_bf16 v[48:63], a[140:143], v[136:139], v[48:63]
    ds_read_b64_tr_b16 v[132:133], v23 offset:16384
    ds_read_b64_tr_b16 v[134:135], v23 offset:16896
    s_min_u32 s34, s34, s3
    s_add_u32 m0, s35, 67584
    s_nop 0
    buffer_load_dwordx4 v14, s[56:59], s34 offen lds
    v_mfma_f32_32x32x16_bf16 v[64:79], a[140:143], v[140:143], v[64:79]
    ds_read_b64_tr_b16 v[136:137], v22 offset:18432
    ds_read_b64_tr_b16 v[138:139], v22 offset:18944
    buffer_load_dwordx4 v15, s[56:59], s34 offen offset:1024 lds
    buffer_load_dwordx4 v16, s[56:59], s34 offen offset:2048 lds
    s_waitcnt lgkmcnt(10)
    s_waitcnt vmcnt(14)
    v_mfma_f32_32x32x16_bf16 v[48:63], a[144:147], v[112:115], v[48:63]
    ds_read_b64_tr_b16 v[140:141], v23 offset:18432
    ds_read_b64_tr_b16 v[142:143], v23 offset:18944
    buffer_load_dwordx4 v17, s[56:59], s34 offen offset:3072 lds
    s_waitcnt lgkmcnt(0)
    s_xor_b64 s[40:41], s[40:41], s[32:33]
    s_xor_b64 s[42:43], s[42:43], s[32:33]
    s_xor_b64 s[44:45], s[44:45], s[32:33]
    s_xor_b64 s[46:47], s[46:47], s[32:33]
    s_or_b64 s[40:41], s[40:41], s[42:43]
    s_or_b64 s[40:41], s[40:41], s[44:45]
    s_or_b64 s[40:41], s[40:41], s[46:47]
    s_cbranch_scc1 Lsr3
Lsd3:
    v_mfma_f32_32x32x16_bf16 v[64:79], a[144:147], v[116:119], v[64:79]
    ds_read_b64_tr_b16 v[112:113], v22 offset:20480
    ds_read_b64_tr_b16 v[114:115], v22 offset:20992
    s_waitcnt vmcnt(14)
    v_mfma_f32_32x32x16_bf16 v[48:63], a[148:151], v[120:123], v[48:63]
    ds_read_b64_tr_b16 v[116:117], v23 offset:20480
    ds_read_b64_tr_b16 v[118:119], v23 offset:20992
    s_and_b32 s31, s6, -32
    s_buffer_load_dwordx8 s[40:47], s[60:63], s31 offset:32 glc
    v_mfma_f32_32x32x16_bf16 v[64:79], a[148:151], v[124:127], v[64:79]
    ds_read_b64_tr_b16 v[120:121], v22 offset:22528
    ds_read_b64_tr_b16 v[122:123], v22 offset:23040
    s_lshl_b32 s30, s75, 12
    s_waitcnt vmcnt(13)
    v_mfma_f32_32x32x16_bf16 v[48:63], a[152:155], v[128:131], v[48:63]
    ds_read_b64_tr_b16 v[124:125], v23 offset:22528
    ds_read_b64_tr_b16 v[126:127], v23 offset:23040
    s_add_u32 s30, s30, s5
    s_xor_b32 s29, s30, 4096
    buffer_load_dwordx4 a[0:3], v31, s[60:63], s29 offen offset:0 sc1
    v_mfma_f32_32x32x16_bf16 v[64:79], a[152:155], v[132:135], v[64:79]
    ds_read_b64_tr_b16 v[128:129], v22 offset:24576
    ds_read_b64_tr_b16 v[130:131], v22 offset:25088
    buffer_load_dwordx4 a[4:7], v31, s[60:63], s29 offen offset:1024 sc1
    buffer_load_dwordx4 a[8:11], v31, s[60:63], s29 offen offset:2048 sc1
    s_waitcnt vmcnt(15)
    v_mfma_f32_32x32x16_bf16 v[48:63], a[156:159], v[136:139], v[48:63]
    ds_read_b64_tr_b16 v[132:133], v23 offset:24576
    ds_read_b64_tr_b16 v[134:135], v23 offset:25088
    buffer_load_dwordx4 a[12:15], v31, s[60:63], s29 offen offset:3072 sc1
    s_xor_b32 s29, s30, 8192
    v_mfma_f32_32x32x16_bf16 v[64:79], a[156:159], v[140:143], v[64:79]
    ds_read_b64_tr_b16 v[136:137], v22 offset:26624
    ds_read_b64_tr_b16 v[138:139], v22 offset:27136
    buffer_load_dwordx4 a[16:19], v31, s[60:63], s29 offen offset:0 sc1
    s_waitcnt lgkmcnt(10)
    s_waitcnt vmcnt(16)
    v_mfma_f32_32x32x16_bf16 v[48:63], a[160:163], v[112:115], v[48:63]
    ds_read_b64_tr_b16 v[140:141], v23 offset:26624
    ds_read_b64_tr_b16 v[142:143], v23 offset:27136
    buffer_load_dwordx4 a[20:23], v31, s[60:63], s29 offen offset:1024 sc1
    v_mfma_f32_32x32x16_bf16 v[64:79], a[160:163], v[116:119], v[64:79]
    ds_read_b64_tr_b16 v[112:113], v22 offset:28672
    ds_read_b64_tr_b16 v[114:115], v22 offset:29184
    buffer_load_dwordx4 a[24:27], v31, s[60:63], s29 offen offset:2048 sc1
    s_waitcnt lgkmcnt(10)
    s_waitcnt vmcnt(17)
    v_mfma_f32_32x32x16_bf16 v[48:63], a[164:167], v[120:123], v[48:63]
    ds_read_b64_tr_b16 v[116:117], v23 offset:28672
    ds_read_b64_tr_b16 v[118:119], v23 offset:29184
    buffer_load_dwordx4 a[28:31], v31, s[60:63], s29 offen offset:3072 sc1
    s_xor_b32 s29, s30, 12288
    v_mfma_f32_32x32x16_bf16 v[64:79], a[164:167], v[124:127], v[64:79]
    ds_read_b64_tr_b16 v[120:121], v22 offset:30720
    ds_read_b64_tr_b16 v[122:123], v22 offset:31232
    buffer_load_dwordx4 a[32:35], v31, s[60:63], s29 offen offset:0 sc1
    s_waitcnt lgkmcnt(10)
    s_waitcnt vmcnt(18)
    v_mfma_f32_32x32x16_bf16 v[48:63], a[168:171], v[128:131], v[48:63]
    ds_read_b64_tr_b16 v[124:125], v23 offset:30720
    ds_read_b64_tr_b16 v[126:127], v23 offset:31232
    buffer_load_dwordx4 a[36:39], v31, s[60:63], s29 offen offset:1024 sc1
    v_mfma_f32_32x32x16_bf16 v[64:79], a[168:171], v[132:135], v[64:79]
    ds_read_b128 v[128:131], v20 offset:0
    buffer_load_dwordx4 a[40:43], v31, s[60:63], s29 offen offset:2048 sc1
    s_waitcnt lgkmcnt(9)
    s_waitcnt vmcnt(19)
    v_mfma_f32_32x32x16_bf16 v[48:63], a[172:175], v[136:139], v[48:63]
    ds_read_b128 v[132:135], v21 offset:0
    buffer_load_dwordx4 a[44:47], v31, s[60:63], s29 offen offset:3072 sc1
    s_xor_b32 s29, s30, 16384
    v_mfma_f32_32x32x16_bf16 v[64:79], a[172:175], v[140:143], v[64:79]
    ds_read_b128 v[136:139], v20 offset:8192
    buffer_load_dwordx4 a[48:51], v31, s[60:63], s29 offen offset:0 sc1
    s_waitcnt lgkmcnt(7)
    s_waitcnt vmcnt(20)
    v_mfma_f32_32x32x16_bf16 v[48:63], a[176:179], v[112:115], v[48:63]
    ds_read_b128 v[140:143], v21 offset:8192
    buffer_load_dwordx4 a[52:55], v31, s[60:63], s29 offen offset:1024 sc1
    v_mfma_f32_32x32x16_bf16 v[64:79], a[176:179], v[116:119], v[64:79]
    ds_read_b128 v[112:115], v18 offset:16384
    buffer_load_dwordx4 a[56:59], v31, s[60:63], s29 offen offset:2048 sc1
    s_waitcnt lgkmcnt(5)
    s_waitcnt vmcnt(21)
    v_mfma_f32_32x32x16_bf16 v[48:63], a[180:183], v[120:123], v[48:63]
    ds_read_b128 v[116:119], v19 offset:16384
    buffer_load_dwordx4 a[60:63], v31, s[60:63], s29 offen offset:3072 sc1
    s_xor_b32 s29, s30, 20480
    v_mfma_f32_32x32x16_bf16 v[64:79], a[180:183], v[124:127], v[64:79]
    ds_read_b128 v[120:123], v18 offset:24576
    buffer_load_dwordx4 a[64:67], v31, s[60:63], s29 offen offset:0 sc1
    s_waitcnt lgkmcnt(5)
    s_waitcnt vmcnt(16)
    v_mfma_f32_32x32x16_bf16 v[48:63], a[0:3], v[128:131], v[48:63]
    ds_read_b128 v[124:127], v19 offset:24576
    buffer_load_dwordx4 a[68:71], v31, s[60:63], s29 offen offset:1024 sc1
    s_waitcnt vmcnt(16)
    v_mfma_f32_32x32x16_bf16 v[48:63], a[4:7], v[132:135], v[48:63]
    ds_read_b128 v[128:131], v20 offset:16384
    buffer_load_dwordx4 a[72:75], v31, s[60:63], s29 offen offset:2048 sc1
    s_waitcnt lgkmcnt(5)
    s_waitcnt vmcnt(16)
    v_mfma_f32_32x32x16_bf16 v[48:63], a[8:11], v[136:139], v[48:63]
    ds_read_b128 v[132:135], v21 offset:16384
    buffer_load_dwordx4 a[76:79], v31, s[60:63], s29 offen offset:3072 sc1
    s_xor_b32 s29, s30, 24576
    s_waitcnt vmcnt(16)
    v_mfma_f32_32x32x16_bf16 v[48:63], a[12:15], v[140:143], v[48:63]
    ds_read_b128 v[136:139], v20 offset:24576
    buffer_load_dwordx4 a[80:83], v31, s[60:63], s29 offen offset:0 sc1
    s_waitcnt lgkmcnt(5)
    s_waitcnt vmcnt(16)
    v_mfma_f32_32x32x16_bf16 v[48:63], a[16:19], v[112:115], v[48:63]
    ds_read_b128 v[140:143], v21 offset:24576
    buffer_load_dwordx4 a[84:87], v31, s[60:63], s29 offen offset:1024 sc1
    s_waitcnt vmcnt(16)
    v_mfma_f32_32x32x16_bf16 v[48:63], a[20:23], v[116:119], v[48:63]
    s_barrier
    ds_read_b128 v[112:115], v10 offset:0
    buffer_load_dwordx4 a[88:91], v31, s[60:63], s29 offen offset:2048 sc1
    s_waitcnt lgkmcnt(5)
    s_waitcnt vmcnt(16)
    v_mfma_f32_32x32x16_bf16 v[48:63], a[24:27], v[120:123], v[48:63]
    ds_read_b128 v[116:119], v11 offset:0
    buffer_load_dwordx4 a[92:95], v31, s[60:63], s29 offen offset:3072 sc1
    s_xor_b32 s29, s30, 28672
    s_waitcnt vmcnt(16)
    v_mfma_f32_32x32x16_bf16 v[48:63], a[28:31], v[124:127], v[48:63]
    ds_read_b128 v[120:123], v10 offset:8192
    buffer_load_dwordx4 a[96:99], v31, s[60:63], s29 offen offset:0 sc1
    s_waitcnt lgkmcnt(5)
    s_waitcnt vmcnt(16)
    v_mfma_f32_32x32x16_bf16 v[48:63], a[32:35], v[128:131], v[48:63]
    ds_read_b128 v[124:127], v11 offset:8192
    buffer_load_dwordx4 a[100:103], v31, s[60:63], s29 offen offset:1024 sc1
    s_waitcnt vmcnt(16)
    v_mfma_f32_32x32x16_bf16 v[48:63], a[36:39], v[132:135], v[48:63]
    ds_read_b128 v[128:131], v12 offset:0
    buffer_load_dwordx4 a[104:107], v31, s[60:63], s29 offen offset:2048 sc1
    s_waitcnt lgkmcnt(5)
    s_waitcnt vmcnt(16)
    v_mfma_f32_32x32x16_bf16 v[48:63], a[40:43], v[136:139], v[48:63]
    ds_read_b128 v[132:135], v13 offset:0
    buffer_load_dwordx4 a[108:111], v31, s[60:63], s29 offen offset:3072 sc1
    s_waitcnt lgkmcnt(0)
    s_xor_b64 s[40:41], s[40:41], s[32:33]
    s_xor_b64 s[42:43], s[42:43], s[32:33]
    s_xor_b64 s[44:45], s[44:45], s[32:33]
    s_xor_b64 s[46:47], s[46:47], s[32:33]
    s_or_b64 s[40:41], s[40:41], s[42:43]
    s_or_b64 s[40:41], s[40:41], s[44:45]
    s_or_b64 s[40:41], s[40:41], s[46:47]
    s_cbranch_scc1 Lsr4
Lsd4:
    s_waitcnt vmcnt(16)
    v_mfma_f32_32x32x16_bf16 v[48:63], a[44:47], v[140:143], v[48:63]
    ds_read_b128 v[136:139], v12 offset:8192
    s_waitcnt vmcnt(15)
    v_mfma_f32_32x32x16_bf16 v[48:63], a[48:51], v[112:115], v[48:63]
    ds_read_b128 v[140:143], v13 offset:8192
    s_and_b32 s31, s6, -32
    s_buffer_load_dwordx8 s[40:47], s[60:63], s31 offset:64 glc
    s_lshl_b32 s30, s75, 11
    s_waitcnt vmcnt(14)
    v_mfma_f32_32x32x16_bf16 v[48:63], a[52:55], v[116:119], v[48:63]
    ds_read_b128 v[112:115], v10 offset:16384
    s_add_u32 s30, s30, s5
    s_add_u32 s30, s30, 49152
    s_xor_b32 s29, s30, 2048
    s_waitcnt vmcnt(13)
    v_mfma_f32_32x32x16_bf16 v[48:63], a[56:59], v[120:123], v[48:63]
    ds_read_b128 v[116:119], v11 offset:16384
    buffer_load_dwordx4 a[184:187], v31, s[60:63], s29 offen offset:0 sc1
    buffer_load_dwordx4 a[188:191], v31, s[60:63], s29 offen offset:1024 sc1
    s_xor_b32 s29, s30, 4096
    s_waitcnt vmcnt(14)
    v_mfma_f32_32x32x16_bf16 v[48:63], a[60:63], v[124:127], v[48:63]
    ds_read_b128 v[120:123], v10 offset:24576
    buffer_load_dwordx4 a[192:195], v31, s[60:63], s29 offen offset:0 sc1
    s_waitcnt vmcnt(14)
    v_mfma_f32_32x32x16_bf16 v[48:63], a[64:67], v[128:131], v[48:63]
    ds_read_b128 v[124:127], v11 offset:24576
    buffer_load_dwordx4 a[196:199], v31, s[60:63], s29 offen offset:1024 sc1
    s_xor_b32 s29, s30, 6144
    s_waitcnt vmcnt(14)
    v_mfma_f32_32x32x16_bf16 v[48:63], a[68:71], v[132:135], v[48:63]
    ds_read_b128 v[128:131], v12 offset:16384
    buffer_load_dwordx4 a[200:203], v31, s[60:63], s29 offen offset:0 sc1
    s_waitcnt lgkmcnt(5)
    s_waitcnt vmcnt(14)
    v_mfma_f32_32x32x16_bf16 v[48:63], a[72:75], v[136:139], v[48:63]
    ds_read_b128 v[132:135], v13 offset:16384
    buffer_load_dwordx4 a[204:207], v31, s[60:63], s29 offen offset:1024 sc1
    s_xor_b32 s29, s30, 8192
    s_waitcnt vmcnt(14)
    v_mfma_f32_32x32x16_bf16 v[48:63], a[76:79], v[140:143], v[48:63]
    ds_read_b128 v[136:139], v12 offset:24576
    buffer_load_dwordx4 a[208:211], v31, s[60:63], s29 offen offset:0 sc1
    s_waitcnt lgkmcnt(5)
    s_waitcnt vmcnt(14)
    v_mfma_f32_32x32x16_bf16 v[48:63], a[80:83], v[112:115], v[48:63]
    ds_read_b128 v[140:143], v13 offset:24576
    buffer_load_dwordx4 a[212:215], v31, s[60:63], s29 offen offset:1024 sc1
    s_xor_b32 s29, s30, 10240
    s_waitcnt vmcnt(14)
    v_mfma_f32_32x32x16_bf16 v[48:63], a[84:87], v[116:119], v[48:63]
    ds_read_b64_tr_b16 v[112:113], v28 offset:4096
    ds_read_b64_tr_b16 v[114:115], v28 offset:4608
    buffer_load_dwordx4 a[216:219], v31, s[60:63], s29 offen offset:0 sc1
    s_waitcnt lgkmcnt(6)
    s_waitcnt vmcnt(14)
    v_mfma_f32_32x32x16_bf16 v[48:63], a[88:91], v[120:123], v[48:63]
    ds_read_b64_tr_b16 v[116:117], v28 offset:6144
    ds_read_b64_tr_b16 v[118:119], v28 offset:6656
    buffer_load_dwordx4 a[220:223], v31, s[60:63], s29 offen offset:1024 sc1
    s_xor_b32 s29, s30, 12288
    s_waitcnt vmcnt(14)
    v_mfma_f32_32x32x16_bf16 v[48:63], a[92:95], v[124:127], v[48:63]
    ds_read_b64_tr_b16 v[120:121], v28 offset:8192
    ds_read_b64_tr_b16 v[122:123], v28 offset:8704
    buffer_load_dwordx4 a[224:227], v31, s[60:63], s29 offen offset:0 sc1
    s_waitcnt lgkmcnt(8)
    s_waitcnt vmcnt(14)
    v_mfma_f32_32x32x16_bf16 v[48:63], a[96:99], v[128:131], v[48:63]
    ds_read_b64_tr_b16 v[124:125], v28 offset:10240
    ds_read_b64_tr_b16 v[126:127], v28 offset:10752
    buffer_load_dwordx4 a[228:231], v31, s[60:63], s29 offen offset:1024 sc1
    s_xor_b32 s29, s30, 14336
    s_waitcnt vmcnt(14)
    v_mfma_f32_32x32x16_bf16 v[48:63], a[100:103], v[132:135], v[48:63]
    ds_read_b64_tr_b16 v[128:129], v28 offset:12288
    ds_read_b64_tr_b16 v[130:131], v28 offset:12800
    buffer_load_dwordx4 a[232:235], v31, s[60:63], s29 offen offset:0 sc1
    s_waitcnt lgkmcnt(10)
    s_waitcnt vmcnt(14)
    v_mfma_f32_32x32x16_bf16 v[48:63], a[104:107], v[136:139], v[48:63]
    ds_read_b64_tr_b16 v[132:133], v28 offset:14336
    ds_read_b64_tr_b16 v[134:135], v28 offset:14848
    buffer_load_dwordx4 a[236:239], v31, s[60:63], s29 offen offset:1024 sc1
    s_waitcnt lgkmcnt(0)
    s_xor_b64 s[40:41], s[40:41], s[32:33]
    s_xor_b64 s[42:43], s[42:43], s[32:33]
    s_xor_b64 s[44:45], s[44:45], s[32:33]
    s_or_b64 s[40:41], s[40:41], s[42:43]
    s_or_b64 s[40:41], s[40:41], s[44:45]
    s_cbranch_scc1 Lsr5
Lsd5:
    s_waitcnt vmcnt(14)
    v_mfma_f32_32x32x16_bf16 v[48:63], a[108:111], v[140:143], v[48:63]
    ds_read_b64_tr_b16 v[136:137], v28 offset:16384
    ds_read_b64_tr_b16 v[138:139], v28 offset:16896
    s_waitcnt vmcnt(13)
    v_mfma_f32_32x32x16_bf16 v[48:63], a[184:187], v[112:115], v[48:63]
    ds_read_b64_tr_b16 v[140:141], v28 offset:18432
    ds_read_b64_tr_b16 v[142:143], v28 offset:18944
    s_add_u32 s29, s5, 65536
    s_waitcnt vmcnt(12)
    v_mfma_f32_32x32x16_bf16 v[48:63], a[188:191], v[116:119], v[48:63]
    ds_read_b64_tr_b16 v[112:113], v28 offset:20480
    ds_read_b64_tr_b16 v[114:115], v28 offset:20992
    buffer_load_dwordx4 a[112:115], v31, s[60:63], s29 offen offset:0 sc1
    buffer_load_dwordx4 a[116:119], v31, s[60:63], s29 offen offset:1024 sc1
    s_waitcnt vmcnt(13)
    v_mfma_f32_32x32x16_bf16 v[48:63], a[192:195], v[120:123], v[48:63]
    ds_read_b64_tr_b16 v[116:117], v28 offset:22528
    ds_read_b64_tr_b16 v[118:119], v28 offset:23040
    buffer_load_dwordx4 a[120:123], v31, s[60:63], s29 offen offset:2048 sc1
    s_waitcnt vmcnt(13)
    v_mfma_f32_32x32x16_bf16 v[48:63], a[196:199], v[124:127], v[48:63]
    ds_read_b64_tr_b16 v[120:121], v28 offset:24576
    ds_read_b64_tr_b16 v[122:123], v28 offset:25088
    buffer_load_dwordx4 a[124:127], v31, s[60:63], s29 offen offset:3072 sc1
    s_add_u32 s29, s5, 69632
    s_waitcnt vmcnt(13)
    v_mfma_f32_32x32x16_bf16 v[48:63], a[200:203], v[128:131], v[48:63]
    ds_read_b64_tr_b16 v[124:125], v28 offset:26624
    ds_read_b64_tr_b16 v[126:127], v28 offset:27136
    buffer_load_dwordx4 a[240:243], v31, s[60:63], s29 offen offset:0 sc1
    s_waitcnt vmcnt(13)
    v_mfma_f32_32x32x16_bf16 v[48:63], a[204:207], v[132:135], v[48:63]
    ds_read_b64_tr_b16 v[128:129], v28 offset:28672
    ds_read_b64_tr_b16 v[130:131], v28 offset:29184
    buffer_load_dwordx4 a[244:247], v31, s[60:63], s29 offen offset:1024 sc1
    s_waitcnt lgkmcnt(10)
    s_waitcnt vmcnt(13)
    v_mfma_f32_32x32x16_bf16 v[48:63], a[208:211], v[136:139], v[48:63]
    ds_read_b64_tr_b16 v[132:133], v28 offset:30720
    ds_read_b64_tr_b16 v[134:135], v28 offset:31232
    buffer_load_dwordx4 v[184:187], v31, s[60:63], s29 offen offset:2048 sc1
    s_waitcnt vmcnt(13)
    v_mfma_f32_32x32x16_bf16 v[48:63], a[212:215], v[140:143], v[48:63]
    ds_read_b64_tr_b16 v[136:137], v22 offset:32768
    ds_read_b64_tr_b16 v[138:139], v22 offset:33280
    buffer_load_dwordx4 v[188:191], v31, s[60:63], s29 offen offset:3072 sc1
    s_add_u32 s29, s5, 73728
    s_waitcnt lgkmcnt(10)
    s_waitcnt vmcnt(13)
    v_mfma_f32_32x32x16_bf16 v[48:63], a[216:219], v[112:115], v[48:63]
    ds_read_b64_tr_b16 v[140:141], v22 offset:34816
    ds_read_b64_tr_b16 v[142:143], v22 offset:35328
    buffer_load_dwordx4 v[192:195], v31, s[60:63], s29 offen offset:0 sc1
    s_waitcnt vmcnt(13)
    v_mfma_f32_32x32x16_bf16 v[48:63], a[220:223], v[116:119], v[48:63]
    ds_read_b64_tr_b16 v[112:113], v22 offset:36864
    ds_read_b64_tr_b16 v[114:115], v22 offset:37376
    buffer_load_dwordx4 v[196:199], v31, s[60:63], s29 offen offset:1024 sc1
    s_waitcnt lgkmcnt(10)
    s_waitcnt vmcnt(13)
    v_mfma_f32_32x32x16_bf16 v[48:63], a[224:227], v[120:123], v[48:63]
    ds_read_b64_tr_b16 v[116:117], v22 offset:38912
    ds_read_b64_tr_b16 v[118:119], v22 offset:39424
    buffer_load_dwordx4 v[104:107], v25, s[60:63], s29 offen offset:2048 sc1
    s_waitcnt vmcnt(13)
    v_mfma_f32_32x32x16_bf16 v[48:63], a[228:231], v[124:127], v[48:63]
    ds_read_b64_tr_b16 v[120:121], v22 offset:40960
    ds_read_b64_tr_b16 v[122:123], v22 offset:41472
    buffer_load_dwordx4 v[108:111], v25, s[60:63], s29 offen offset:3072 sc1
    s_lshl_b32 s29, s75, 7
    s_waitcnt lgkmcnt(10)
    s_waitcnt vmcnt(13)
    v_mfma_f32_32x32x16_bf16 v[48:63], a[232:235], v[128:131], v[48:63]
    ds_read_b64_tr_b16 v[124:125], v22 offset:43008
    ds_read_b64_tr_b16 v[126:127], v22 offset:43520
    s_lshl_b32 s30, s74, 6
    s_add_u32 s29, s29, s30
    s_add_u32 s29, s29, s7
    s_waitcnt vmcnt(12)
    v_mfma_f32_32x32x16_bf16 v[48:63], a[236:239], v[132:135], v[48:63]
    ds_read_b64_tr_b16 v[128:129], v22 offset:45056
    ds_read_b64_tr_b16 v[130:131], v22 offset:45568
    buffer_load_ushort v200, v27, s[36:39], s29 offen offset:0
    buffer_load_ushort v202, v27, s[36:39], s29 offen offset:1024
    s_waitcnt lgkmcnt(10)
    s_waitcnt vmcnt(13)
    v_mfma_f32_32x32x16_bf16 v[48:63], a[112:115], v[136:139], v[48:63]
    ds_read_b64_tr_b16 v[132:133], v22 offset:47104
    ds_read_b64_tr_b16 v[134:135], v22 offset:47616
    buffer_load_ushort v204, v27, s[36:39], s29 offen offset:2048
    buffer_load_ushort v206, v27, s[36:39], s29 offen offset:3072
    s_add_u32 s29, s29, 4096
    s_waitcnt vmcnt(14)
    v_mfma_f32_32x32x16_bf16 v[48:63], a[116:119], v[140:143], v[48:63]
    ds_read_b64_tr_b16 v[136:137], v22 offset:49152
    ds_read_b64_tr_b16 v[138:139], v22 offset:49664
    buffer_load_ushort v208, v27, s[36:39], s29 offen offset:0
    buffer_load_ushort v210, v27, s[36:39], s29 offen offset:1024
    s_waitcnt lgkmcnt(10)
    s_waitcnt vmcnt(15)
    v_mfma_f32_32x32x16_bf16 v[48:63], a[120:123], v[112:115], v[48:63]
    ds_read_b64_tr_b16 v[140:141], v22 offset:51200
    ds_read_b64_tr_b16 v[142:143], v22 offset:51712
    buffer_load_ushort v212, v27, s[36:39], s29 offen offset:2048
    buffer_load_ushort v214, v27, s[36:39], s29 offen offset:3072
    s_add_u32 s29, s29, 4096
    s_waitcnt vmcnt(16)
    v_mfma_f32_32x32x16_bf16 v[48:63], a[124:127], v[116:119], v[48:63]
    ds_read_b64_tr_b16 v[112:113], v22 offset:53248
    ds_read_b64_tr_b16 v[114:115], v22 offset:53760
    buffer_load_ushort v201, v27, s[36:39], s29 offen offset:0
    buffer_load_ushort v203, v27, s[36:39], s29 offen offset:1024
    s_waitcnt lgkmcnt(10)
    s_waitcnt vmcnt(17)
    v_mfma_f32_32x32x16_bf16 v[48:63], a[240:243], v[120:123], v[48:63]
    ds_read_b64_tr_b16 v[116:117], v22 offset:55296
    ds_read_b64_tr_b16 v[118:119], v22 offset:55808
    buffer_load_ushort v205, v27, s[36:39], s29 offen offset:2048
    buffer_load_ushort v207, v27, s[36:39], s29 offen offset:3072
    s_add_u32 s29, s29, 4096
    s_waitcnt vmcnt(18)
    v_mfma_f32_32x32x16_bf16 v[48:63], a[244:247], v[124:127], v[48:63]
    ds_read_b128 v[120:123], v20 offset:4096
    buffer_load_ushort v209, v27, s[36:39], s29 offen offset:0
    buffer_load_ushort v211, v27, s[36:39], s29 offen offset:1024
    buffer_load_ushort v213, v27, s[36:39], s29 offen offset:2048
    s_waitcnt lgkmcnt(9)
    s_waitcnt vmcnt(20)
    v_mfma_f32_32x32x16_bf16 v[48:63], v[184:187], v[128:131], v[48:63]
    ds_read_b128 v[124:127], v21 offset:4096
    buffer_load_ushort v215, v27, s[36:39], s29 offen offset:3072
    ds_read_b128 v[232:235], v41 offset:0
    ds_read_b128 v[236:239], v41 offset:32
    ds_read_b128 v[240:243], v41 offset:64
    s_waitcnt vmcnt(20)
    v_mfma_f32_32x32x16_bf16 v[48:63], v[188:191], v[132:135], v[48:63]
    ds_read_b128 v[128:131], v20 offset:12288
    ds_read_b128 v[244:247], v41 offset:96
    ds_read_b128 v[216:219], v41 offset:128
    ds_read_b128 v[220:223], v41 offset:160
    s_waitcnt lgkmcnt(13)
    s_waitcnt vmcnt(19)
    v_mfma_f32_32x32x16_bf16 v[48:63], v[192:195], v[136:139], v[48:63]
    ds_read_b128 v[132:135], v21 offset:12288
    ds_read_b128 v[224:227], v41 offset:192
    ds_read_b128 v[228:231], v41 offset:224
    s_waitcnt vmcnt(18)
    v_mfma_f32_32x32x16_bf16 v[48:63], v[196:199], v[140:143], v[48:63]
    ds_read_b128 v[136:139], v18 offset:20480
    s_waitcnt lgkmcnt(13)
    s_waitcnt vmcnt(17)
    v_mfma_f32_32x32x16_bf16 v[48:63], v[104:107], v[112:115], v[48:63]
    ds_read_b128 v[140:143], v19 offset:20480
    s_waitcnt vmcnt(16)
    v_mfma_f32_32x32x16_bf16 v[48:63], v[108:111], v[116:119], v[48:63]
    ds_read_b128 v[112:115], v18 offset:28672
    s_waitcnt lgkmcnt(13)
    v_mfma_f32_32x32x16_bf16 v[64:79], a[0:3], v[120:123], v[64:79]
    ds_read_b128 v[116:119], v19 offset:28672
    v_mfma_f32_32x32x16_bf16 v[64:79], a[4:7], v[124:127], v[64:79]
    ds_read_b128 v[120:123], v20 offset:20480
    s_nop 5
    v_max3_f32 v9, |v48|, |v49|, |v50|
    v_max3_f32 v80, |v51|, |v52|, |v53|
    v_max3_f32 v9, v9, |v54|, |v55|
    s_waitcnt lgkmcnt(7)
    v_mfma_f32_32x32x16_bf16 v[64:79], a[8:11], v[128:131], v[64:79]
    ds_read_b128 v[124:127], v21 offset:20480
    v_max3_f32 v80, v80, |v56|, |v57|
    v_max3_f32 v9, v9, |v58|, |v59|
    v_max3_f32 v80, v80, |v60|, |v61|
    v_max3_f32 v9, v9, |v62|, |v63|
    v_max_f32 v9, v9, v80
    v_lshrrev_b32 v9, 23, v9
    v_min_u32 v9, 252, v9
    v_sub_u32 v94, 253, v9
    v_lshlrev_b32 v94, 23, v94
    v_lshl_or_b32 v9, v9, 14, v9
    v_pk_mul_f32 v[80:81], v[48:49], v[94:95] op_sel_hi:[1,0]
    v_cvt_pknorm_i16_f32 v80, v80, v81
    v_bfi_b32 v80, s23, v9, v80
    v_pk_mul_f32 v[82:83], v[50:51], v[94:95] op_sel_hi:[1,0]
    v_cvt_pknorm_i16_f32 v81, v82, v83
    v_bfi_b32 v81, s23, v6, v81
    v_pk_mul_f32 v[84:85], v[52:53], v[94:95] op_sel_hi:[1,0]
    v_cvt_pknorm_i16_f32 v82, v84, v85
    v_bfi_b32 v82, s23, v7, v82
    v_pk_mul_f32 v[86:87], v[54:55], v[94:95] op_sel_hi:[1,0]
    v_cvt_pknorm_i16_f32 v83, v86, v87
    v_bfi_b32 v83, s23, v8, v83
    buffer_store_dwordx4 v[80:83], v31, s[60:63], s24 offen offset:0 sc1
    v_pk_mul_f32 v[88:89], v[56:57], v[94:95] op_sel_hi:[1,0]
    v_cvt_pknorm_i16_f32 v84, v88, v89
    v_lshrrev_b32 v9, 4, v9
    v_bfi_b32 v84, s23, v9, v84
    v_pk_mul_f32 v[90:91], v[58:59], v[94:95] op_sel_hi:[1,0]
    v_cvt_pknorm_i16_f32 v85, v90, v91
    v_bfi_b32 v85, s23, v6, v85
    v_pk_mul_f32 v[92:93], v[60:61], v[94:95] op_sel_hi:[1,0]
    v_cvt_pknorm_i16_f32 v86, v92, v93
    v_bfi_b32 v86, s23, v7, v86
    v_pk_mul_f32 v[94:95], v[62:63], v[94:95] op_sel_hi:[1,0]
    v_cvt_pknorm_i16_f32 v87, v94, v95
    v_bfi_b32 v87, s23, v8, v87
    buffer_store_dwordx4 v[84:87], v31, s[60:63], s24 offen offset:1024 sc1
    s_xor_b32 s23, s24, 2048
    v_mfma_f32_32x32x16_bf16 v[64:79], a[12:15], v[132:135], v[64:79]
    ds_read_b128 v[128:131], v20 offset:28672
    s_waitcnt lgkmcnt(5)
    v_mfma_f32_32x32x16_bf16 v[64:79], a[16:19], v[136:139], v[64:79]
    ds_read_b128 v[132:135], v21 offset:28672
    v_mfma_f32_32x32x16_bf16 v[64:79], a[20:23], v[140:143], v[64:79]
    ds_read_b128 v[136:139], v10 offset:4096
    s_waitcnt lgkmcnt(5)
    v_mfma_f32_32x32x16_bf16 v[64:79], a[24:27], v[112:115], v[64:79]
    ds_read_b128 v[140:143], v11 offset:4096
    v_mfma_f32_32x32x16_bf16 v[64:79], a[28:31], v[116:119], v[64:79]
    ds_read_b128 v[112:115], v10 offset:12288
    s_waitcnt lgkmcnt(5)
    v_mfma_f32_32x32x16_bf16 v[64:79], a[32:35], v[120:123], v[64:79]
    ds_read_b128 v[116:119], v11 offset:12288
    v_mfma_f32_32x32x16_bf16 v[64:79], a[36:39], v[124:127], v[64:79]
    ds_read_b128 v[120:123], v12 offset:4096
    s_waitcnt lgkmcnt(5)
    v_mfma_f32_32x32x16_bf16 v[64:79], a[40:43], v[128:131], v[64:79]
    ds_read_b128 v[124:127], v13 offset:4096
    v_mfma_f32_32x32x16_bf16 v[64:79], a[44:47], v[132:135], v[64:79]
    ds_read_b128 v[128:131], v12 offset:12288
    s_waitcnt lgkmcnt(5)
    v_mfma_f32_32x32x16_bf16 v[64:79], a[48:51], v[136:139], v[64:79]
    ds_read_b128 v[132:135], v13 offset:12288
    v_mfma_f32_32x32x16_bf16 v[64:79], a[52:55], v[140:143], v[64:79]
    ds_read_b128 v[136:139], v10 offset:20480
    s_waitcnt lgkmcnt(5)
    v_mfma_f32_32x32x16_bf16 v[64:79], a[56:59], v[112:115], v[64:79]
    ds_read_b128 v[140:143], v11 offset:20480
    v_mfma_f32_32x32x16_bf16 v[64:79], a[60:63], v[116:119], v[64:79]
    ds_read_b128 v[112:115], v10 offset:28672
    s_waitcnt lgkmcnt(5)
    v_mfma_f32_32x32x16_bf16 v[64:79], a[64:67], v[120:123], v[64:79]
    ds_read_b128 v[116:119], v11 offset:28672
    v_mfma_f32_32x32x16_bf16 v[64:79], a[68:71], v[124:127], v[64:79]
    ds_read_b128 v[120:123], v12 offset:20480
    s_waitcnt lgkmcnt(5)
    v_mfma_f32_32x32x16_bf16 v[64:79], a[72:75], v[128:131], v[64:79]
    ds_read_b128 v[124:127], v13 offset:20480
    v_mfma_f32_32x32x16_bf16 v[64:79], a[76:79], v[132:135], v[64:79]
    ds_read_b128 v[128:131], v12 offset:28672
    s_waitcnt lgkmcnt(5)
    v_mfma_f32_32x32x16_bf16 v[64:79], a[80:83], v[136:139], v[64:79]
    ds_read_b128 v[132:135], v13 offset:28672
    v_mfma_f32_32x32x16_bf16 v[64:79], a[84:87], v[140:143], v[64:79]
    ds_read_b64_tr_b16 v[136:137], v29 offset:4096
    ds_read_b64_tr_b16 v[138:139], v29 offset:4608
    s_waitcnt lgkmcnt(6)
    v_mfma_f32_32x32x16_bf16 v[64:79], a[88:91], v[112:115], v[64:79]
    ds_read_b64_tr_b16 v[140:141], v29 offset:6144
    ds_read_b64_tr_b16 v[142:143], v29 offset:6656
    v_mfma_f32_32x32x16_bf16 v[64:79], a[92:95], v[116:119], v[64:79]
    ds_read_b64_tr_b16 v[112:113], v29 offset:8192
    ds_read_b64_tr_b16 v[114:115], v29 offset:8704
    s_waitcnt lgkmcnt(8)
    v_mfma_f32_32x32x16_bf16 v[64:79], a[96:99], v[120:123], v[64:79]
    ds_read_b64_tr_b16 v[116:117], v29 offset:10240
    ds_read_b64_tr_b16 v[118:119], v29 offset:10752
    v_mfma_f32_32x32x16_bf16 v[64:79], a[100:103], v[124:127], v[64:79]
    ds_read_b64_tr_b16 v[120:121], v29 offset:12288
    ds_read_b64_tr_b16 v[122:123], v29 offset:12800
    s_waitcnt lgkmcnt(10)
    v_mfma_f32_32x32x16_bf16 v[64:79], a[104:107], v[128:131], v[64:79]
    ds_read_b64_tr_b16 v[124:125], v29 offset:14336
    ds_read_b64_tr_b16 v[126:127], v29 offset:14848
    v_mfma_f32_32x32x16_bf16 v[64:79], a[108:111], v[132:135], v[64:79]
    ds_read_b64_tr_b16 v[128:129], v29 offset:16384
    ds_read_b64_tr_b16 v[130:131], v29 offset:16896
    s_waitcnt lgkmcnt(10)
    v_mfma_f32_32x32x16_bf16 v[64:79], a[184:187], v[136:139], v[64:79]
    ds_read_b64_tr_b16 v[132:133], v29 offset:18432
    ds_read_b64_tr_b16 v[134:135], v29 offset:18944
    v_mfma_f32_32x32x16_bf16 v[64:79], a[188:191], v[140:143], v[64:79]
    ds_read_b64_tr_b16 v[136:137], v29 offset:20480
    ds_read_b64_tr_b16 v[138:139], v29 offset:20992
    s_waitcnt lgkmcnt(10)
    v_mfma_f32_32x32x16_bf16 v[64:79], a[192:195], v[112:115], v[64:79]
    ds_read_b64_tr_b16 v[140:141], v29 offset:22528
    ds_read_b64_tr_b16 v[142:143], v29 offset:23040
    v_mfma_f32_32x32x16_bf16 v[64:79], a[196:199], v[116:119], v[64:79]
    ds_read_b64_tr_b16 v[112:113], v29 offset:24576
    ds_read_b64_tr_b16 v[114:115], v29 offset:25088
    s_waitcnt lgkmcnt(10)
    v_mfma_f32_32x32x16_bf16 v[64:79], a[200:203], v[120:123], v[64:79]
    ds_read_b64_tr_b16 v[116:117], v29 offset:26624
    ds_read_b64_tr_b16 v[118:119], v29 offset:27136
    v_mfma_f32_32x32x16_bf16 v[64:79], a[204:207], v[124:127], v[64:79]
    ds_read_b64_tr_b16 v[120:121], v29 offset:28672
    ds_read_b64_tr_b16 v[122:123], v29 offset:29184
    s_waitcnt lgkmcnt(10)
    v_mfma_f32_32x32x16_bf16 v[64:79], a[208:211], v[128:131], v[64:79]
    ds_read_b64_tr_b16 v[124:125], v29 offset:30720
    ds_read_b64_tr_b16 v[126:127], v29 offset:31232
    v_mfma_f32_32x32x16_bf16 v[64:79], a[212:215], v[132:135], v[64:79]
    ds_read_b64_tr_b16 v[128:129], v23 offset:32768
    ds_read_b64_tr_b16 v[130:131], v23 offset:33280
    s_waitcnt lgkmcnt(10)
    v_mfma_f32_32x32x16_bf16 v[64:79], a[216:219], v[136:139], v[64:79]
    ds_read_b64_tr_b16 v[132:133], v23 offset:34816
    ds_read_b64_tr_b16 v[134:135], v23 offset:35328
    buffer_load_dwordx4 v[160:163], v31, s[60:63], s23 offen offset:0 sc1
    buffer_load_dwordx4 v[164:167], v31, s[60:63], s23 offen offset:1024 sc1
    v_mfma_f32_32x32x16_bf16 v[64:79], a[220:223], v[140:143], v[64:79]
    ds_read_b64_tr_b16 v[136:137], v23 offset:36864
    ds_read_b64_tr_b16 v[138:139], v23 offset:37376
    s_waitcnt vmcnt(4)
    v_lshlrev_b32 v42, 16, v42
    s_waitcnt lgkmcnt(10)
    v_mfma_f32_32x32x16_bf16 v[64:79], a[224:227], v[112:115], v[64:79]
    ds_read_b64_tr_b16 v[140:141], v23 offset:38912
    ds_read_b64_tr_b16 v[142:143], v23 offset:39424
    v_lshlrev_b32 v200, 16, v200
    v_mul_f32 v232, v232, v42
    v_sub_f32 v216, v200, v216
    v_mfma_f32_32x32x16_bf16 v[64:79], a[228:231], v[116:119], v[64:79]
    ds_read_b64_tr_b16 v[112:113], v23 offset:40960
    ds_read_b64_tr_b16 v[114:115], v23 offset:41472
    v_fmac_f32 v200, v216, v232
    v_lshlrev_b32 v201, 16, v201
    s_waitcnt lgkmcnt(10)
    v_mfma_f32_32x32x16_bf16 v[64:79], a[232:235], v[120:123], v[64:79]
    ds_read_b64_tr_b16 v[116:117], v23 offset:43008
    ds_read_b64_tr_b16 v[118:119], v23 offset:43520
    v_mul_f32 v233, v233, v42
    v_sub_f32 v217, v201, v217
    v_fmac_f32 v201, v217, v233
    v_mfma_f32_32x32x16_bf16 v[64:79], a[236:239], v[124:127], v[64:79]
    ds_read_b64_tr_b16 v[120:121], v23 offset:45056
    ds_read_b64_tr_b16 v[122:123], v23 offset:45568
    v_lshlrev_b32 v202, 16, v202
    v_mul_f32 v234, v234, v42
    s_waitcnt lgkmcnt(10)
    v_mfma_f32_32x32x16_bf16 v[64:79], a[112:115], v[128:131], v[64:79]
    ds_read_b64_tr_b16 v[124:125], v23 offset:47104
    ds_read_b64_tr_b16 v[126:127], v23 offset:47616
    v_sub_f32 v218, v202, v218
    v_fmac_f32 v202, v218, v234
    v_lshlrev_b32 v203, 16, v203
    v_mfma_f32_32x32x16_bf16 v[64:79], a[116:119], v[132:135], v[64:79]
    ds_read_b64_tr_b16 v[128:129], v23 offset:49152
    ds_read_b64_tr_b16 v[130:131], v23 offset:49664
    v_mul_f32 v235, v235, v42
    v_sub_f32 v219, v203, v219
    s_waitcnt lgkmcnt(10)
    v_mfma_f32_32x32x16_bf16 v[64:79], a[120:123], v[136:139], v[64:79]
    ds_read_b64_tr_b16 v[132:133], v23 offset:51200
    ds_read_b64_tr_b16 v[134:135], v23 offset:51712
    v_fmac_f32 v203, v219, v235
    v_lshlrev_b32 v204, 16, v204
    v_mul_f32 v236, v236, v42
    v_mfma_f32_32x32x16_bf16 v[64:79], a[124:127], v[140:143], v[64:79]
    ds_read_b64_tr_b16 v[136:137], v23 offset:53248
    ds_read_b64_tr_b16 v[138:139], v23 offset:53760
    v_sub_f32 v220, v204, v220
    v_fmac_f32 v204, v220, v236
    s_waitcnt lgkmcnt(10)
    v_mfma_f32_32x32x16_bf16 v[64:79], a[240:243], v[112:115], v[64:79]
    ds_read_b64_tr_b16 v[140:141], v23 offset:55296
    ds_read_b64_tr_b16 v[142:143], v23 offset:55808
    v_lshlrev_b32 v205, 16, v205
    v_mul_f32 v237, v237, v42
    v_sub_f32 v221, v205, v221
    v_mfma_f32_32x32x16_bf16 v[64:79], a[244:247], v[116:119], v[64:79]
    v_fmac_f32 v205, v221, v237
    v_lshlrev_b32 v206, 16, v206
    v_mul_f32 v238, v238, v42
    v_sub_f32 v222, v206, v222
    s_waitcnt lgkmcnt(8)
    v_mfma_f32_32x32x16_bf16 v[64:79], v[184:187], v[120:123], v[64:79]
    v_fmac_f32 v206, v222, v238
    v_lshlrev_b32 v207, 16, v207
    v_mul_f32 v239, v239, v42
    v_sub_f32 v223, v207, v223
    v_fmac_f32 v207, v223, v239
    v_mfma_f32_32x32x16_bf16 v[64:79], v[188:191], v[124:127], v[64:79]
    v_lshlrev_b32 v208, 16, v208
    v_mul_f32 v240, v240, v42
    v_sub_f32 v224, v208, v224
    v_fmac_f32 v208, v224, v240
    s_waitcnt lgkmcnt(4)
    v_mfma_f32_32x32x16_bf16 v[64:79], v[192:195], v[128:131], v[64:79]
    v_lshlrev_b32 v209, 16, v209
    v_mul_f32 v241, v241, v42
    v_sub_f32 v225, v209, v225
    v_fmac_f32 v209, v225, v241
    v_lshlrev_b32 v210, 16, v210
    v_mfma_f32_32x32x16_bf16 v[64:79], v[196:199], v[132:135], v[64:79]
    v_mul_f32 v242, v242, v42
    v_sub_f32 v226, v210, v226
    v_fmac_f32 v210, v226, v242
    v_lshlrev_b32 v211, 16, v211
    s_waitcnt lgkmcnt(0)
    v_mfma_f32_32x32x16_bf16 v[64:79], v[104:107], v[136:139], v[64:79]
    v_mul_f32 v243, v243, v42
    v_sub_f32 v227, v211, v227
    v_fmac_f32 v211, v227, v243
    v_lshlrev_b32 v212, 16, v212
    v_mul_f32 v244, v244, v42
    v_mfma_f32_32x32x16_bf16 v[64:79], v[108:111], v[140:143], v[64:79]
    v_sub_f32 v228, v212, v228
    v_fmac_f32 v212, v228, v244
    v_lshlrev_b32 v213, 16, v213
    v_mul_f32 v245, v245, v42
    v_sub_f32 v229, v213, v229
    v_fmac_f32 v213, v229, v245
    v_lshlrev_b32 v214, 16, v214
    v_mul_f32 v246, v246, v42
    v_sub_f32 v230, v214, v230
    v_fmac_f32 v214, v230, v246
    v_lshlrev_b32 v215, 16, v215
    v_mul_f32 v247, v247, v42
    v_sub_f32 v231, v215, v231
    v_fmac_f32 v215, v231, v247
    s_lshl_b32 s20, s73, 16
    s_lshl_b32 s21, s75, 8
    s_add_u32 s20, s20, s21
    s_lshl_b32 s21, s74, 7
    s_add_u32 s20, s20, s21
    v_pk_add_f32 v[64:65], v[64:65], v[200:201]
    v_pk_add_f32 v[66:67], v[66:67], v[202:203]
    v_pk_add_f32 v[68:69], v[68:69], v[204:205]
    v_pk_add_f32 v[70:71], v[70:71], v[206:207]
    v_pk_add_f32 v[72:73], v[72:73], v[208:209]
    v_pk_add_f32 v[74:75], v[74:75], v[210:211]
    v_pk_add_f32 v[76:77], v[76:77], v[212:213]
    v_pk_add_f32 v[78:79], v[78:79], v[214:215]
    s_mov_b32 s24, 0x30003
    s_mov_b32 s25, 0xfffcfffc
    s_mov_b32 s26, 0x800000
    s_waitcnt vmcnt(0)
    v_xor_b32 v2, v161, v6
    v_xor_b32 v3, v165, v6
    v_bitop3_b32 v2, v2, v162, v7 bitop3:0xf6
    v_bitop3_b32 v3, v3, v166, v7 bitop3:0xf6
    v_bitop3_b32 v2, v2, v163, v8 bitop3:0xf6
    v_bitop3_b32 v3, v3, v167, v8 bitop3:0xf6
    v_or_b32 v2, v2, v3
    v_and_b32 v2, s24, v2
    v_cmp_ne_u32 vcc, 0, v2
    s_or_b64 s[30:31], vcc, vcc
    s_cbranch_scc0 Ldone7
Lretry7:
    s_cmp_eq_u32 s72, 0
    s_cbranch_scc1 Ldone7
    s_sub_u32 s72, s72, 1
    buffer_load_dwordx4 v[160:163], v31, s[60:63], s23 offen offset:0 sc1
    buffer_load_dwordx4 v[164:167], v31, s[60:63], s23 offen offset:1024 sc1
    s_waitcnt vmcnt(0)
    v_xor_b32 v2, v161, v6
    v_xor_b32 v3, v165, v6
    v_bitop3_b32 v2, v2, v162, v7 bitop3:0xf6
    v_bitop3_b32 v3, v3, v166, v7 bitop3:0xf6
    v_bitop3_b32 v2, v2, v163, v8 bitop3:0xf6
    v_bitop3_b32 v3, v3, v167, v8 bitop3:0xf6
    v_or_b32 v2, v2, v3
    v_and_b32 v2, s24, v2
    v_cmp_ne_u32 vcc, 0, v2
    s_or_b64 s[30:31], vcc, vcc
    s_cbranch_scc1 Lretry7
Ldone7:
    v_and_b32 v2, s24, v160
    v_and_b32 v3, s24, v164
    v_lshl_or_b32 v2, v3, 4, v2
    v_lshrrev_b32 v3, 14, v2
    v_or_b32 v2, v2, v3
    v_lshl_add_u32 v2, v2, 23, s26
    v_mul_f32 v2, 0x38000100, v2
    v_and_b32 v160, s25, v160
    v_cvt_f32_i32_sdwa v168, sext(v160) dst_sel:DWORD dst_unused:UNUSED_PAD src0_sel:WORD_0
    v_fmac_f32 v64, v168, v2
    buffer_store_dword v64, v26, s[64:67], s20 offen offset:0 sc1
    v_and_b32 v161, s25, v161
    v_cvt_f32_i32_sdwa v169, sext(v161) dst_sel:DWORD dst_unused:UNUSED_PAD src0_sel:WORD_0
    v_fmac_f32 v66, v169, v2
    buffer_store_dword v66, v26, s[64:67], s20 offen offset:2048 sc1
    s_add_u32 s20, s20, 4096
    v_and_b32 v162, s25, v162
    v_cvt_f32_i32_sdwa v170, sext(v162) dst_sel:DWORD dst_unused:UNUSED_PAD src0_sel:WORD_0
    v_fmac_f32 v68, v170, v2
    buffer_store_dword v68, v26, s[64:67], s20 offen offset:0 sc1
    v_and_b32 v163, s25, v163
    v_cvt_f32_i32_sdwa v171, sext(v163) dst_sel:DWORD dst_unused:UNUSED_PAD src0_sel:WORD_0
    v_fmac_f32 v70, v171, v2
    buffer_store_dword v70, v26, s[64:67], s20 offen offset:2048 sc1
    s_add_u32 s20, s20, 4096
    v_and_b32 v164, s25, v164
    v_cvt_f32_i32_sdwa v172, sext(v164) dst_sel:DWORD dst_unused:UNUSED_PAD src0_sel:WORD_0
    v_fmac_f32 v72, v172, v2
    buffer_store_dword v72, v26, s[64:67], s20 offen offset:0 sc1
    v_and_b32 v165, s25, v165
    v_cvt_f32_i32_sdwa v173, sext(v165) dst_sel:DWORD dst_unused:UNUSED_PAD src0_sel:WORD_0
    v_fmac_f32 v74, v173, v2
    buffer_store_dword v74, v26, s[64:67], s20 offen offset:2048 sc1
    s_add_u32 s20, s20, 4096
    v_and_b32 v166, s25, v166
    v_cvt_f32_i32_sdwa v174, sext(v166) dst_sel:DWORD dst_unused:UNUSED_PAD src0_sel:WORD_0
    v_fmac_f32 v76, v174, v2
    buffer_store_dword v76, v26, s[64:67], s20 offen offset:0 sc1
    v_and_b32 v167, s25, v167
    v_cvt_f32_i32_sdwa v175, sext(v167) dst_sel:DWORD dst_unused:UNUSED_PAD src0_sel:WORD_0
    v_fmac_f32 v78, v175, v2
    buffer_store_dword v78, v26, s[64:67], s20 offen offset:2048 sc1
    s_add_u32 s20, s20, 4096
    v_cvt_f32_i32_sdwa v168, sext(v160) dst_sel:DWORD dst_unused:UNUSED_PAD src0_sel:WORD_1
    v_fmac_f32 v65, v168, v2
    buffer_store_dword v65, v26, s[64:67], s20 offen offset:0 sc1
    v_cvt_f32_i32_sdwa v169, sext(v161) dst_sel:DWORD dst_unused:UNUSED_PAD src0_sel:WORD_1
    v_fmac_f32 v67, v169, v2
    buffer_store_dword v67, v26, s[64:67], s20 offen offset:2048 sc1
    s_add_u32 s20, s20, 4096
    v_cvt_f32_i32_sdwa v170, sext(v162) dst_sel:DWORD dst_unused:UNUSED_PAD src0_sel:WORD_1
    v_fmac_f32 v69, v170, v2
    buffer_store_dword v69, v26, s[64:67], s20 offen offset:0 sc1
    v_cvt_f32_i32_sdwa v171, sext(v163) dst_sel:DWORD dst_unused:UNUSED_PAD src0_sel:WORD_1
    v_fmac_f32 v71, v171, v2
    buffer_store_dword v71, v26, s[64:67], s20 offen offset:2048 sc1
    s_add_u32 s20, s20, 4096
    v_cvt_f32_i32_sdwa v172, sext(v164) dst_sel:DWORD dst_unused:UNUSED_PAD src0_sel:WORD_1
    v_fmac_f32 v73, v172, v2
    buffer_store_dword v73, v26, s[64:67], s20 offen offset:0 sc1
    v_cvt_f32_i32_sdwa v173, sext(v165) dst_sel:DWORD dst_unused:UNUSED_PAD src0_sel:WORD_1
    v_fmac_f32 v75, v173, v2
    buffer_store_dword v75, v26, s[64:67], s20 offen offset:2048 sc1
    s_add_u32 s20, s20, 4096
    v_cvt_f32_i32_sdwa v174, sext(v166) dst_sel:DWORD dst_unused:UNUSED_PAD src0_sel:WORD_1
    v_fmac_f32 v77, v174, v2
    buffer_store_dword v77, v26, s[64:67], s20 offen offset:0 sc1
    v_cvt_f32_i32_sdwa v175, sext(v167) dst_sel:DWORD dst_unused:UNUSED_PAD src0_sel:WORD_1
    v_fmac_f32 v79, v175, v2
    buffer_store_dword v79, v26, s[64:67], s20 offen offset:2048 sc1
    s_lshl_b32 s3, s68, 4
    s_add_u32 s3, s3, s69
    s_lshl_b32 s3, s3, 2
    s_add_u32 s3, s3, s70
    s_cmp_lg_u32 s3, 960
    s_cbranch_scc1 L_NG
    v_mov_b32 v15, 294912
    s_mov_b64 exec, 1
    buffer_store_dword v43, v15, s[60:63], 0 offen sc1
    s_mov_b64 exec, -1
L_NG:
L_END:
    s_endpgm
Lsr3:
    s_and_b32 s31, s6, -32
    s_mov_b32 s30, 8
Lss3:
    s_sub_u32 s72, s72, 1
    s_buffer_load_dwordx8 s[40:47], s[60:63], s31 offset:96 glc
    s_waitcnt lgkmcnt(0)
    s_xor_b64 s[40:41], s[40:41], s[32:33]
    s_xor_b64 s[42:43], s[42:43], s[32:33]
    s_xor_b64 s[44:45], s[44:45], s[32:33]
    s_xor_b64 s[46:47], s[46:47], s[32:33]
    s_or_b64 s[40:41], s[40:41], s[42:43]
    s_or_b64 s[40:41], s[40:41], s[44:45]
    s_or_b64 s[40:41], s[40:41], s[46:47]
    s_cbranch_scc0 Lsd3
    s_sub_u32 s30, s30, 1
    s_cmp_lg_u32 s30, 0
    s_cbranch_scc1 Lss3
Lsv3:
    s_cmp_lt_i32 s72, 1
    s_cbranch_scc1 Lsd3
    s_sub_u32 s72, s72, 1
    buffer_load_dword v24, v40, s[60:63], 0 offen sc1
    s_waitcnt vmcnt(0)
    v_cmp_ne_u32 vcc, s71, v24
    s_and_b32 s31, vcc_lo, 0xff000000
    s_cbranch_scc1 Lsv3
    s_branch Lsd3
Lsr4:
    s_and_b32 s31, s6, -32
    s_mov_b32 s30, 8
Lss4:
    s_sub_u32 s72, s72, 1
    s_buffer_load_dwordx8 s[40:47], s[60:63], s31 offset:32 glc
    s_waitcnt lgkmcnt(0)
    s_xor_b64 s[40:41], s[40:41], s[32:33]
    s_xor_b64 s[42:43], s[42:43], s[32:33]
    s_xor_b64 s[44:45], s[44:45], s[32:33]
    s_xor_b64 s[46:47], s[46:47], s[32:33]
    s_or_b64 s[40:41], s[40:41], s[42:43]
    s_or_b64 s[40:41], s[40:41], s[44:45]
    s_or_b64 s[40:41], s[40:41], s[46:47]
    s_cbranch_scc0 Lsd4
    s_sub_u32 s30, s30, 1
    s_cmp_lg_u32 s30, 0
    s_cbranch_scc1 Lss4
Lsv4:
    s_cmp_lt_i32 s72, 1
    s_cbranch_scc1 Lsd4
    s_sub_u32 s72, s72, 1
    buffer_load_dword v24, v40, s[60:63], 0 offen sc1
    s_waitcnt vmcnt(0)
    v_cmp_ne_u32 vcc, s71, v24
    s_and_b32 s31, vcc_lo, 0xff00
    s_cbranch_scc1 Lsv4
    s_branch Lsd4
Lsr5:
    s_and_b32 s31, s6, -32
    s_mov_b32 s30, 8
Lss5:
    s_sub_u32 s72, s72, 1
    s_buffer_load_dwordx8 s[40:47], s[60:63], s31 offset:64 glc
    s_waitcnt lgkmcnt(0)
    s_xor_b64 s[40:41], s[40:41], s[32:33]
    s_xor_b64 s[42:43], s[42:43], s[32:33]
    s_xor_b64 s[44:45], s[44:45], s[32:33]
    s_or_b64 s[40:41], s[40:41], s[42:43]
    s_or_b64 s[40:41], s[40:41], s[44:45]
    s_cbranch_scc0 Lsd5
    s_sub_u32 s30, s30, 1
    s_cmp_lg_u32 s30, 0
    s_cbranch_scc1 Lss5
Lsv5:
    s_cmp_lt_i32 s72, 1
    s_cbranch_scc1 Lsd5
    s_sub_u32 s72, s72, 1
    buffer_load_dword v24, v40, s[60:63], 0 offen sc1
    s_waitcnt vmcnt(0)
    v_cmp_ne_u32 vcc, s71, v24
    s_and_b32 s31, vcc_lo, 0x3f0000
    s_cbranch_scc1 Lsv5
    s_branch Lsd5
.section .rodata,"a"
.p2align 6
.amdhsa_kernel parallel_sum__ssm_conv_s5__dense_activation_relu__prompt_kernel
  .amdhsa_next_free_vgpr 512
  .amdhsa_next_free_sgpr 102
  .amdhsa_accum_offset 256
  .amdhsa_group_segment_fixed_size 0
  .amdhsa_kernarg_size 120
  .amdhsa_user_sgpr_count 2
  .amdhsa_user_sgpr_kernarg_segment_ptr 1
  .amdhsa_system_sgpr_workgroup_id_x 1
.end_amdhsa_kernel
```
